```python
import torch

def _softmax(x, axis=-1):
    return torch.softmax(x, dim=axis)
def _gelu(x):
    return torch.nn.functional.gelu(x, approximate="tanh")
def _silu(x):
    return torch.nn.functional.silu(x)
def _sigmoid(x):
    return torch.sigmoid(x)
def _layernorm(x, axis=-1, eps=1e-5):
    m = x.mean(dim=axis, keepdim=True)
    v = x.var(dim=axis, keepdim=True, unbiased=False)
    return (x - m) / torch.sqrt(v + eps)
def _scatter_add(tgt, idx, src, axis=0):
    return tgt.clone().index_add_(axis, idx, src)
def _segment_sum(src, seg, n):
    out = torch.zeros((n,) + src.shape[1:], dtype=src.dtype)
    return out.index_add_(0, seg, src)
def _pad(x, pw):
    flat = tuple(v for pair in reversed(pw) for v in pair)
    return torch.nn.functional.pad(x, flat)

kernel_name = 'concat_heads__ssm_conv_s4d__spectral_gfnet__prompt'

def setup_inputs():

    _w = (lambda a: (lambda t: t.to(torch.bfloat16) if t.is_floating_point() else t)(torch.as_tensor(a)))
    def _A_setup():
        Bsz, L, D, N = 1, 2048, 576, 128
        return {
            "u": _w((lambda *s: torch.randn(*s, dtype=torch.bfloat16) * 0.05)(Bsz, L, D)),
            "log_A_real": _w((lambda *s: torch.randn(*s, dtype=torch.bfloat16) * 6.4)(D, N) * 0.5),
            "A_imag": _w((lambda *s: torch.randn(*s, dtype=torch.bfloat16) * 0.05)(D, N) * 3.14),
            "C_real": _w((lambda *s: torch.randn(*s, dtype=torch.bfloat16) * 0.05)(D, N) / N ** 0.5),
            "C_imag": _w((lambda *s: torch.randn(*s, dtype=torch.bfloat16) * 0.05)(D, N) / N ** 0.5),
            "log_dt": _w((lambda *s: torch.randn(*s, dtype=torch.bfloat16) * 0.05)(D) * 0.5 - 4.0),
            "D_skip": _w((lambda *s: torch.randn(*s, dtype=torch.bfloat16) * 0.05)(D)),
        }
    _A_in = _A_setup()

    def _B_setup():
        B, S, D = 1, 2048, 576
        Df = D // 2 + 1
        return {
            "x": _w((lambda *s: torch.randn(*s, dtype=torch.bfloat16) * 0.05)(B, S, D)),
            "w_r": _w((lambda *s: torch.randn(*s, dtype=torch.bfloat16) * 0.8)(S, Df) * 0.02),
            "w_i": _w((lambda *s: torch.randn(*s, dtype=torch.bfloat16) * 0.8)(S, Df) * 0.02),
        }
    _B_in = _B_setup()

    return {
        "A_u": _A_in["u"],
        "A_log_A_real": _A_in["log_A_real"],
        "A_A_imag": _A_in["A_imag"],
        "A_C_real": _A_in["C_real"],
        "A_C_imag": _A_in["C_imag"],
        "A_log_dt": _A_in["log_dt"],
        "A_D_skip": _A_in["D_skip"],
        "B_x": _B_in["x"],
        "B_w_r": _B_in["w_r"],
        "B_w_i": _B_in["w_i"],
    }

def reference(A_u, A_log_A_real, A_A_imag, A_C_real, A_C_imag, A_log_dt, A_D_skip, B_x, B_w_r, B_w_i):
    def _A_ref(u, log_A_real, A_imag, C_real, C_imag, log_dt, D_skip):
        L = u.shape[1]
        dt = torch.exp(log_dt)
        A = -torch.exp(log_A_real) + 1j * A_imag
        C = (C_real + 1j * C_imag) * dt[:, None]
        pos = (lambda x, dt: x.to(dt))(torch.arange(L), log_dt.dtype)
        P = torch.exp((A * dt[:, None])[:, :, None] * pos[None, None, :])
        K = 2.0 * torch.einsum("dn,dnl->dl", C, P).real
        L2 = 2 * L
        u_t = (lambda x, *d: x.permute(*d))(u, 0, 2, 1)
        Kf = (lambda x, *a, **k: torch.fft.rfft(x.float(), *a, **k))(K, L2)
        Uf = (lambda x, *a, **k: torch.fft.rfft(x.float(), *a, **k))(u_t, L2)
        y = (lambda x, *a, **k: torch.fft.irfft(x, *a, **k).to(torch.bfloat16))(Uf * Kf[None, :, :], L2)[:, :, :L]
        y = (lambda x, *d: x.permute(*d))(y, 0, 2, 1)
        return y + u * D_skip[None, None, :]

    def _B_ref(x, w_r, w_i):
        B, S, D = x.shape
        X = (lambda x, axes=(-2,-1): torch.fft.rfft2(x.float(), dim=axes))(x, axes=(-2, -1))
        W = w_r + 1j * w_i
        X = X * W
        y = (lambda x, s, axes=(-2,-1): torch.fft.irfft2(x, s=s, dim=axes).to(torch.bfloat16))(X, (S, D), axes=(-2, -1))
        return y

    a = _A_ref(A_u, A_log_A_real, A_A_imag, A_C_real, A_C_imag, A_log_dt, A_D_skip)
    b = _B_ref(B_x, B_w_r, B_w_i)
    return torch.concatenate([a, b], axis=-1)
```

```asm
; @launch grid=(512,1,1) block=(512,1,1) lds=81920
.amdgcn_target "amdgcn-amd-amdhsa--gfx950"
.text
.globl concat_heads__ssm_conv_s4d__spectral_gfnet__prompt_kernel
.p2align 8
.type concat_heads__ssm_conv_s4d__spectral_gfnet__prompt_kernel,@function
concat_heads__ssm_conv_s4d__spectral_gfnet__prompt_kernel:
L_start:
  s_cmp_ge_u32 s2, 512
  s_cbranch_scc1 L_exit
  s_load_dwordx16 s[8:23], s[0:1], 0
  s_load_dwordx8 s[24:31], s[0:1], 64
  s_load_dwordx2 s[32:33], s[0:1], 96
  v_readfirstlane_b32 s3, v0
  s_getpc_b64 s[34:35]
L_pc:
  v_and_b32 v1, 63, v0
  s_lshr_b32 s3, s3, 6
  v_lshlrev_b32 v2, 4, v1
  v_mov_b32 v3, 0
  s_lshr_b32 s36, s2, 8
  s_or_b32 s36, s36, s3
  s_cbranch_scc1 L_nowarm
  s_lshr_b32 s36, s2, 3
  s_mul_i32 s36, s36, 1792
  s_add_u32 s38, s34, s36
  s_addc_u32 s39, s35, 0
  v_lshl_add_u64 v[4:5], v[2:3], 3, s[38:39]
  s_mov_b64 exec, 0x3fff
  global_load_dword v63, v[4:5], off
  s_mov_b64 exec, -1
L_nowarm:
  s_add_u32 s34, s34, L_tables-L_pc
  s_addc_u32 s35, s35, 0
  s_movk_i32 s96, 0x4000
  s_mov_b32 s97, 0xfffefffe
  s_mov_b32 s98, 0x10000
  s_mov_b32 s99, 0x10001
  s_cmp_ge_u32 s2, 256
  s_cbranch_scc1 L_A2
  s_mov_b32 s95, 0x8000
  s_cmp_ge_u32 s2, 128
  s_cbranch_scc1 L_AUX
  s_setprio 2
  s_lshl_b32 s36, s3, 11
  s_add_u32 m0, s36, 38912
  s_add_u32 s38, s34, s36
  s_addc_u32 s39, s35, 0
  v_lshl_add_u64 v[4:5], v[2:3], 0, s[38:39]
  global_load_lds_dwordx4 v[4:5], off
  global_load_lds_dwordx4 v[4:5], off offset:1024
  s_mov_b64 s[44:45], 0xff
  v_add_u32 v7, 146304, v2
  s_and_b32 s63, s2, 0x60
  s_bfe_u32 s36, s2, 0x30002
  s_add_u32 s63, s63, s36
  s_and_b32 s37, s2, 3
  s_lshl3_add_u32 s63, s37, s63
  v_cndmask_b32 v6, v7, v2, s[44:45]
  s_lshl_b32 s62, s3, 8
  s_add_u32 s62, s62, s63
  s_mul_i32 s36, s62, 1152
  s_mul_i32 s40, s3, 2304
  s_add_u32 s40, s40, 20480
  s_mov_b32 m0, s40
  s_waitcnt lgkmcnt(0)
  s_add_u32 s38, s22, s36
  s_addc_u32 s39, s23, 0
  global_load_lds_dwordx4 v2, s[38:39]
  global_load_lds_dwordx4 v6, s[38:39] offset:1024
  s_mov_b64 exec, 0xffff
  global_load_lds_dwordx4 v7, s[38:39] offset:2048
  s_mov_b64 exec, -1
  s_branch L_B1
L_A2:
  s_sub_u32 s56, s2, 256
  s_lshr_b32 s36, s3, 2
  s_lshl1_add_u32 s62, s56, s36
  s_and_b32 s57, s56, 31
  s_lshr_b32 s58, s56, 5
  v_lshrrev_b32 v18, 3, v0
  v_and_b32 v19, 0x70, v2
  s_movk_i32 s36, 1152
  v_mad_u32_u24 v17, v18, s36, v19
  v_mad_u32_u24 v123, v18, s36, v17
  s_mul_i32 s45, s57, 73728
  s_lshl_b32 s44, s58, 7
  s_add_u32 s46, s45, s44
  v_and_b32 v16, 127, v0
  s_lshl_b32 s36, s62, 7
  v_add_lshl_u32 v16, v16, s36, 1
  s_and_b32 s47, s62, -2
  s_lshl_b32 s47, s47, 1
  s_waitcnt lgkmcnt(0)
  global_load_ushort v50, v16, s[10:11]
  global_load_ushort v51, v16, s[12:13]
  global_load_ushort v52, v16, s[14:15]
  global_load_ushort v53, v16, s[16:17]
  s_load_dword s63, s[18:19], s47
  s_add_u32 s38, s8, s46
  s_addc_u32 s39, s9, 0
  global_load_dwordx4 v[124:127], v17, s[38:39]
  s_branch L_A2b
L_AUX:
  s_mov_b32 s59, 0
  s_cmp_lt_u32 s2, 224
  s_cbranch_scc1 L_aux1
  s_mov_b32 s59, 1
  s_add_u32 s56, s2, 32
  s_and_b32 s57, s56, 31
  s_lshr_b32 s58, s56, 5
  v_lshrrev_b32 v18, 3, v0
  v_and_b32 v19, 0x70, v2
  s_movk_i32 s36, 1152
  v_mad_u32_u24 v17, v18, s36, v19
  v_mad_u32_u24 v123, v18, s36, v17
  s_mul_i32 s45, s57, 73728
  s_lshl_b32 s44, s58, 7
  s_add_u32 s46, s45, s44
  s_waitcnt lgkmcnt(0)
  s_add_u32 s38, s8, s46
  s_addc_u32 s39, s9, 0
  global_load_dwordx4 v[124:127], v17, s[38:39]
  v_lshl_or_b32 v122, v18, 12, v19
  s_add_u32 s36, s45, s46
  s_add_u32 s28, s28, s36
  s_addc_u32 s29, s29, 0
  s_add_u32 s20, s20, s44
  s_addc_u32 s21, s21, 0
  s_lshl_b32 s36, s58, 18
  s_lshl_b32 s37, s57, 7
  s_add_u32 s36, s36, s37
  s_add_u32 s36, s36, 2621440
  s_add_u32 s60, s32, s36
  s_addc_u32 s61, s33, 0
  s_lshl_b32 s36, s3, 4
  v_xor_b32 v120, s36, v2
  v_xor_b32 v121, s36, v19
  v_lshl_add_u32 v121, v19, 6, v121
  v_lshrrev_b32 v18, 3, v1
  v_lshl_add_u32 v121, v18, 1, v121
  v_bfe_u32 v18, v1, 2, 1
  s_mov_b32 s37, 36864
  v_mad_u32_u24 v121, v18, s37, v121
  s_lshr_b32 s36, s3, 2
  s_mul_i32 s36, s36, s37
  s_lshl_b32 s37, s3, 10
  s_add_u32 s36, s36, s37
  v_add_u32 v120, s36, v120
L_aux1:
  s_cmp_lt_u32 s3, 4
  s_cbranch_scc1 L_aux2
  s_bfe_u32 s36, s2, 0x40003
  s_and_b32 s37, s3, 1
  s_lshl1_add_u32 s36, s36, s37
  s_lshl_b32 s36, s36, 6
  s_and_b32 s37, s2, 7
  s_add_u32 s36, s36, s37
  s_mul_i32 s36, s36, 578
  s_and_b32 s36, s36, -4
  v_and_b32 v9, 7, v1
  v_lshlrev_b32 v9, 7, v9
  v_min_u32 v9, 576, v9
  v_lshrrev_b32 v10, 3, v1
  s_movk_i32 s37, 4624
  v_mad_u32_u24 v9, v10, s37, v9
  s_mov_b32 s50, 1183744
  s_mov_b32 s51, 0x20000
  s_cmp_lt_u32 s3, 6
  s_waitcnt lgkmcnt(0)
  s_cselect_b64 s[48:49], s[24:25], s[26:27]
  buffer_load_dword v62, v3, s[48:51], s36 offen offset:0
  s_waitcnt vmcnt(0)
  buffer_load_dword v62, v9, s[48:51], s36 offen
  s_mov_b64 exec, -1
  s_sub_u32 s36, s2, 160
  s_cmp_lt_u32 s36, 64
  s_cbranch_scc1 L_end
L_aux2:
  s_sub_u32 s36, s2, 160
  s_cmp_ge_u32 s36, 64
  s_cbranch_scc1 L_aux3
  s_add_u32 s62, s36, 512
  v_and_b32 v16, 127, v0
  s_lshl_b32 s36, s62, 7
  v_add_lshl_u32 v16, v16, s36, 1
  s_and_b32 s47, s62, -2
  s_lshl_b32 s47, s47, 1
  s_waitcnt lgkmcnt(0)
  global_load_ushort v50, v16, s[10:11]
  global_load_ushort v51, v16, s[12:13]
  global_load_ushort v52, v16, s[14:15]
  global_load_ushort v53, v16, s[16:17]
  s_load_dword s63, s[18:19], s47
  s_branch L_A1b
L_B1:
  s_lshl1_add_u32 s36, s36, 1152
  s_add_u32 s28, s28, s36
  s_addc_u32 s29, s29, 0
  s_lshr_b32 s36, s2, 2
  s_mul_i32 s36, s36, 20
  s_add_u32 s36, s36, s3
  s_lshl2_add_u32 s36, s36, s37
  s_lshl_b32 s36, s36, 10
  s_add_u32 s56, s32, s36
  s_addc_u32 s57, s33, 0
  v_and_b32 v8, 0xf0, v2
  v_lshrrev_b32 v9, 4, v1
  s_movk_i32 s36, 20480
  v_mad_u32_u24 v4, v9, s36, v8
  v_and_b32 v8, 0xf0, v2
  v_lshrrev_b32 v9, 4, v1
  v_cvt_f32_u32 v8, v8
  v_cvt_f32_u32 v9, v9
  v_cvt_f32_u32 v10, s3
  v_mul_f32 v8, 0x3b800000, v8
  v_mul_f32 v9, 4.0, v9
  v_mul_f32 v10, 0x3e000000, v10
  v_add_f32 v11, v9, v10
  v_mul_f32 v11, v11, v8
  v_cos_f32 v20, v11
  v_sin_f32 v21, v11
  v_add_f32 v11, v11, v8
  v_cvt_pk_bf16_f32 v12, v20, v21
  v_cos_f32 v20, v11
  v_sin_f32 v21, v11
  v_add_f32 v11, v11, v8
  v_cvt_pk_bf16_f32 v13, v20, v21
  v_cos_f32 v20, v11
  v_sin_f32 v21, v11
  v_add_f32 v11, v11, v8
  v_cvt_pk_bf16_f32 v14, v20, v21
  v_cos_f32 v20, v11
  v_sin_f32 v21, v11
  s_nop 0
  v_cvt_pk_bf16_f32 v15, v20, v21
  v_lshl_add_u32 v23, s3, 11, v2
  ds_write_b128 v23, v[12:15] offset:63488
  s_cmp_lt_u32 s3, 6
  s_cbranch_scc1 L_nom16
  v_cvt_f32_u32 v22, s63
  v_mul_f32 v22, 0x3a000000, v22
  s_cmp_eq_u32 s3, 6
  s_cselect_b32 s36, 0x41800000, 0
  s_cselect_b32 s37, 0, 1.0
  v_mul_f32 v11, v8, v22
  v_mul_f32 v11, s36, v11
  v_fma_f32 v22, v22, s37, v8
  v_fma_f32 v11, v9, v22, v11
  v_cos_f32 v20, v11
  v_sin_f32 v21, v11
  v_add_f32 v11, v11, v22
  v_cvt_pk_bf16_f32 v24, v20, v21
  v_cvt_pk_bf16_f32 v28, -v21, v20
  v_cos_f32 v20, v11
  v_sin_f32 v21, v11
  v_add_f32 v11, v11, v22
  v_cvt_pk_bf16_f32 v25, v20, v21
  v_cvt_pk_bf16_f32 v29, -v21, v20
  v_cos_f32 v20, v11
  v_sin_f32 v21, v11
  v_add_f32 v11, v11, v22
  v_cvt_pk_bf16_f32 v26, v20, v21
  v_cvt_pk_bf16_f32 v30, -v21, v20
  v_cos_f32 v20, v11
  v_sin_f32 v21, v11
  s_nop 0
  v_cvt_pk_bf16_f32 v27, v20, v21
  v_cvt_pk_bf16_f32 v31, -v21, v20
  ds_write_b128 v23, v[24:27] offset:47104
  ds_write_b128 v23, v[28:31] offset:48128
L_nom16:
  v_fmamk_f32 v10, v10, 0x3d800000, v8
  v_mul_f32 v11, v9, v10
  v_cos_f32 v20, v11
  v_sin_f32 v21, v11
  v_add_f32 v11, v11, v10
  v_cvt_pk_bf16_f32 v16, v20, v21
  v_cos_f32 v20, v11
  v_sin_f32 v21, v11
  v_add_f32 v11, v11, v10
  v_cvt_pk_bf16_f32 v17, v20, v21
  v_cos_f32 v20, v11
  v_sin_f32 v21, v11
  v_add_f32 v11, v11, v10
  v_cvt_pk_bf16_f32 v18, v20, v21
  v_cos_f32 v20, v11
  v_sin_f32 v21, v11
  s_nop 0
  v_cvt_pk_bf16_f32 v19, v20, v21
  ds_write_b128 v23, v[16:19] offset:64512
  s_and_b32 s46, s2, 15
  s_lshr_b32 s47, s2, 4
  s_and_b32 s36, s3, 3
  s_lshl_b32 s36, s36, 9
  s_add_u32 s36, s36, s46
  s_mul_i32 s36, s36, 578
  s_and_b32 s54, s36, 2
  s_sub_u32 s36, s36, s54
  s_lshl3_add_u32 s54, s3, s54
  s_mul_i32 s37, s47, 60
  s_add_u32 s52, s36, s37
  v_lshrrev_b32 v5, 2, v1
  v_and_b32 v6, 8, v5
  v_add_u32 v5, v5, v6
  v_lshlrev_b32 v6, 1, v1
  v_xor_b32 v6, v6, v2
  v_and_b32 v6, 48, v6
  s_mul_i32 s53, s3, 2056
  s_movk_i32 s36, 9248
  v_mad_u32_u24 v5, v5, s36, v6
  s_cmp_lt_u32 s3, 4
  s_cselect_b64 s[48:49], s[24:25], s[26:27]
  s_mov_b32 s50, 1183744
  s_mov_b32 s51, 0x20000
  s_bfe_u32 s36, s2, 0x20002
  s_lshl2_add_u32 s36, s3, s36
  s_mul_i32 s36, s36, 5
  s_lshr_b32 s37, s2, 5
  s_add_u32 s36, s36, s37
  s_and_b32 s37, s2, 3
  s_lshl4_add_u32 s36, s36, s37
  s_and_b32 s37, s47, 1
  s_lshl1_add_u32 s36, s36, s37
  s_lshl_b32 s36, s36, 7
  s_add_u32 s42, s32, s36
  s_addc_u32 s43, s33, 0
  s_lshl3_add_u32 s55, s47, s3
  v_lshrrev_b32 v32, 2, v2
  s_mov_b64 exec, 0xffff
  ds_write_b32 v32, v3 offset:20224
  s_mov_b64 exec, -1
  s_waitcnt vmcnt(3) lgkmcnt(0)
  s_barrier
  ds_read_b128 v[64:67], v2 offset:38912
  ds_read_b128 v[68:71], v2 offset:39936
  ds_read_b128 v[72:75], v2 offset:40960
  ds_read_b128 v[76:79], v2 offset:41984
  ds_read_b128 v[80:83], v2 offset:43008
  ds_read_b128 v[84:87], v2 offset:44032
  ds_read_b128 v[88:91], v2 offset:45056
  v_bfe_u32 v7, v1, 1, 1
  s_movk_i32 s37, 1136
  s_lshl_b32 s41, s3, 10
  s_waitcnt lgkmcnt(6)
  v_add_u32_sdwa v6, s40, v67 dst_sel:DWORD dst_unused:UNUSED_PAD src0_sel:DWORD src1_sel:WORD_0
  v_add_u32_sdwa v0, s41, v67 dst_sel:DWORD dst_unused:UNUSED_PAD src0_sel:DWORD src1_sel:WORD_1
  v_mad_u32_u24 v7, v7, s37, v6
  s_lshl_b32 s36, s3, 3
  v_xor_b32_sdwa v58, s36, v64 dst_sel:DWORD dst_unused:UNUSED_PAD src0_sel:DWORD src1_sel:WORD_0
  v_xor_b32_sdwa v59, s36, v64 dst_sel:DWORD dst_unused:UNUSED_PAD src0_sel:DWORD src1_sel:WORD_1
  v_xor_b32_sdwa v60, s36, v65 dst_sel:DWORD dst_unused:UNUSED_PAD src0_sel:DWORD src1_sel:WORD_0
  v_xor_b32_sdwa v61, s36, v65 dst_sel:DWORD dst_unused:UNUSED_PAD src0_sel:DWORD src1_sel:WORD_1
  v_xor_b32_sdwa v62, s36, v66 dst_sel:DWORD dst_unused:UNUSED_PAD src0_sel:DWORD src1_sel:WORD_0
  v_xor_b32_sdwa v63, s36, v66 dst_sel:DWORD dst_unused:UNUSED_PAD src0_sel:DWORD src1_sel:WORD_1
  v_xor_b32 v64, 16, v0
  v_xor_b32 v65, 32, v0
  v_xor_b32 v66, 48, v0
  s_waitcnt vmcnt(0)
  ds_read_b64_tr_b16 v[8:9], v6
  ds_read_b64_tr_b16 v[10:11], v6 offset:192
  ds_read_b64_tr_b16 v[12:13], v6 offset:1152
  ds_read_b64_tr_b16 v[14:15], v6 offset:1344
  ds_read_b64_tr_b16 v[16:17], v7 offset:32
  ds_read_b64_tr_b16 v[18:19], v7 offset:224
  ds_read_b128 v[92:95], v2 offset:46080
  ds_read_b128 v[104:107], v2 offset:49152
  ds_read_b128 v[116:119], v2 offset:52224
  ds_read_b128 v[96:99], v2 offset:47104
  ds_read_b128 v[100:103], v2 offset:48128
  ds_read_b128 v[108:111], v2 offset:50176
  ds_read_b128 v[112:115], v2 offset:51200
  ds_read_b128 v[120:123], v2 offset:53248
  ds_read_b128 v[124:127], v2 offset:54272
  s_waitcnt lgkmcnt(13)
  v_mfma_f32_16x16x32_bf16 v[20:23], v[8:11], v[68:71], 0
  v_mfma_f32_16x16x32_bf16 v[24:27], v[8:11], v[72:75], 0
  s_waitcnt lgkmcnt(11)
  v_mfma_f32_16x16x32_bf16 v[28:31], v[12:15], v[68:71], 0
  v_mfma_f32_16x16x32_bf16 v[32:35], v[12:15], v[72:75], 0
  s_waitcnt lgkmcnt(9)
  v_mfma_f32_16x16x32_bf16 v[36:39], v[16:19], v[68:71], 0
  v_mfma_f32_16x16x32_bf16 v[40:43], v[16:19], v[72:75], 0
  ds_read_b128 v[68:71], v2 offset:59392
  ds_read_b128 v[72:75], v2 offset:60416
  v_mul_f32 v56, v20, v76
  v_mul_f32 v57, v21, v77
  v_fmac_f32 v56, v24, v80
  v_fmac_f32 v57, v25, v81
  v_mul_f32 v24, v24, v76
  v_mul_f32 v25, v25, v77
  v_fma_f32 v24, -v20, v80, v24
  v_fma_f32 v25, -v21, v81, v25
  v_cvt_pk_bf16_f32 v44, v56, v24
  v_cvt_pk_bf16_f32 v45, v57, v25
  v_mul_f32 v56, v22, v78
  v_mul_f32 v57, v23, v79
  v_fmac_f32 v56, v26, v82
  v_fmac_f32 v57, v27, v83
  v_mul_f32 v26, v26, v78
  v_mul_f32 v27, v27, v79
  v_fma_f32 v26, -v22, v82, v26
  v_fma_f32 v27, -v23, v83, v27
  v_cvt_pk_bf16_f32 v46, v56, v26
  v_cvt_pk_bf16_f32 v47, v57, v27
  s_waitcnt lgkmcnt(2)
  s_nop 0
  v_mfma_f32_16x16x32_bf16 v[8:11], v[92:95], v[44:47], 0
  v_mul_f32 v56, v28, v76
  v_mul_f32 v57, v29, v77
  v_fmac_f32 v56, v32, v80
  v_fmac_f32 v57, v33, v81
  v_mul_f32 v32, v32, v76
  v_mul_f32 v33, v33, v77
  v_mfma_f32_16x16x32_bf16 v[12:15], v[104:107], v[44:47], 0
  v_fma_f32 v32, -v28, v80, v32
  v_fma_f32 v33, -v29, v81, v33
  v_cvt_pk_bf16_f32 v48, v56, v32
  v_cvt_pk_bf16_f32 v49, v57, v33
  v_mul_f32 v56, v30, v78
  v_mul_f32 v57, v31, v79
  v_fmac_f32 v56, v34, v82
  v_mfma_f32_16x16x32_bf16 v[16:19], v[116:119], v[44:47], 0
  v_fmac_f32 v57, v35, v83
  v_mul_f32 v34, v34, v78
  v_mul_f32 v35, v35, v79
  v_fma_f32 v34, -v30, v82, v34
  v_fma_f32 v35, -v31, v83, v35
  v_cvt_pk_bf16_f32 v50, v56, v34
  v_cvt_pk_bf16_f32 v51, v57, v35
  s_nop 1
  v_mfma_f32_16x16x32_bf16 v[20:23], v[92:95], v[48:51], 0
  v_mul_f32 v56, v36, v84
  v_mul_f32 v57, v37, v85
  v_fmac_f32 v56, v40, v88
  v_fmac_f32 v57, v41, v89
  v_mul_f32 v40, v40, v84
  v_mul_f32 v41, v41, v85
  v_mfma_f32_16x16x32_bf16 v[24:27], v[104:107], v[48:51], 0
  v_fma_f32 v40, -v36, v88, v40
  v_fma_f32 v41, -v37, v89, v41
  v_cvt_pk_bf16_f32 v52, v56, v40
  v_cvt_pk_bf16_f32 v53, v57, v41
  v_mul_f32 v56, v38, v86
  v_mul_f32 v57, v39, v87
  v_fmac_f32 v56, v42, v90
  v_mfma_f32_16x16x32_bf16 v[28:31], v[116:119], v[48:51], 0
  v_fmac_f32 v57, v43, v91
  v_mul_f32 v42, v42, v86
  v_mul_f32 v43, v43, v87
  v_fma_f32 v42, -v38, v90, v42
  v_fma_f32 v43, -v39, v91, v43
  v_cvt_pk_bf16_f32 v54, v56, v42
  v_cvt_pk_bf16_f32 v55, v57, v43
  s_nop 1
  v_mfma_f32_16x16x32_bf16 v[8:11], v[96:99], v[52:55], v[8:11]
  v_mfma_f32_16x16x32_bf16 v[20:23], v[100:103], v[52:55], v[20:23]
  v_mfma_f32_16x16x32_bf16 v[12:15], v[108:111], v[52:55], v[12:15]
  v_mfma_f32_16x16x32_bf16 v[24:27], v[112:115], v[52:55], v[24:27]
  v_mfma_f32_16x16x32_bf16 v[16:19], v[120:123], v[52:55], v[16:19]
  v_mfma_f32_16x16x32_bf16 v[28:31], v[124:127], v[52:55], v[28:31]
  s_nop 2
  v_cvt_pk_bf16_f32 v32, v8, v9
  v_cvt_pk_bf16_f32 v33, v20, v21
  ds_write_b64 v58, v[32:33]
  v_cvt_pk_bf16_f32 v34, v10, v11
  v_cvt_pk_bf16_f32 v35, v22, v23
  ds_write_b64 v59, v[34:35]
  v_cvt_pk_bf16_f32 v36, v12, v13
  v_cvt_pk_bf16_f32 v37, v24, v25
  ds_write_b64 v60, v[36:37]
  v_cvt_pk_bf16_f32 v38, v14, v15
  v_cvt_pk_bf16_f32 v39, v26, v27
  ds_write_b64 v61, v[38:39]
  v_cvt_pk_bf16_f32 v40, v16, v17
  v_cvt_pk_bf16_f32 v41, v28, v29
  ds_write_b64 v62, v[40:41]
  v_cvt_pk_bf16_f32 v42, v18, v19
  v_cvt_pk_bf16_f32 v43, v30, v31
  ds_write_b64 v63, v[42:43]
  s_cmp_ge_u32 s3, 5
  s_waitcnt lgkmcnt(0)
  s_barrier
  s_cbranch_scc1 L_P2
  ds_read_b128 v[8:11], v0 offset:0
  ds_read_b128 v[12:15], v64 offset:5120
  ds_read_b128 v[16:19], v65 offset:10240
  ds_read_b128 v[20:23], v66 offset:15360
  s_waitcnt lgkmcnt(3)
  v_mfma_f32_16x16x32_bf16 v[32:35], v[68:71], v[8:11], 0
  v_mfma_f32_16x16x32_bf16 v[36:39], v[72:75], v[8:11], 0
  s_waitcnt lgkmcnt(2)
  v_mfma_f32_16x16x32_bf16 v[40:43], v[68:71], v[12:15], 0
  v_mfma_f32_16x16x32_bf16 v[44:47], v[72:75], v[12:15], 0
  s_waitcnt lgkmcnt(1)
  v_mfma_f32_16x16x32_bf16 v[48:51], v[68:71], v[16:19], 0
  v_mfma_f32_16x16x32_bf16 v[52:55], v[72:75], v[16:19], 0
  s_waitcnt lgkmcnt(0)
  v_mfma_f32_16x16x32_bf16 v[56:59], v[68:71], v[20:23], 0
  v_mfma_f32_16x16x32_bf16 v[60:63], v[72:75], v[20:23], 0
  v_cvt_pk_bf16_f32 v112, v32, v36
  v_cvt_pk_bf16_f32 v116, v33, v37
  v_cvt_pk_bf16_f32 v120, v34, v38
  v_cvt_pk_bf16_f32 v124, v35, v39
  v_bitop3_b32 v112, v112, s97, 1 bitop3:0xea
  v_bitop3_b32 v116, v116, s97, 1 bitop3:0xea
  v_bitop3_b32 v120, v120, s97, 1 bitop3:0xea
  v_bitop3_b32 v124, v124, s97, 1 bitop3:0xea
  v_cvt_pk_bf16_f32 v113, v40, v44
  v_cvt_pk_bf16_f32 v117, v41, v45
  v_cvt_pk_bf16_f32 v121, v42, v46
  v_cvt_pk_bf16_f32 v125, v43, v47
  v_or_b32 v113, s99, v113
  v_or_b32 v117, s99, v117
  v_or_b32 v121, s99, v121
  v_or_b32 v125, s99, v125
  v_cvt_pk_bf16_f32 v114, v48, v52
  v_cvt_pk_bf16_f32 v118, v49, v53
  v_cvt_pk_bf16_f32 v122, v50, v54
  v_cvt_pk_bf16_f32 v126, v51, v55
  v_bitop3_b32 v114, v114, -2, s98 bitop3:0xea
  v_bitop3_b32 v118, v118, -2, s98 bitop3:0xea
  v_bitop3_b32 v122, v122, -2, s98 bitop3:0xea
  v_bitop3_b32 v126, v126, -2, s98 bitop3:0xea
  v_cvt_pk_bf16_f32 v115, v56, v60
  v_and_b32 v115, s97, v115
  global_store_dwordx4 v4, v[112:115], s[56:57] offset:0 sc1
  v_cvt_pk_bf16_f32 v119, v57, v61
  v_and_b32 v119, s97, v119
  global_store_dwordx4 v4, v[116:119], s[56:57] offset:256 sc1
  v_cvt_pk_bf16_f32 v123, v58, v62
  v_and_b32 v123, s97, v123
  global_store_dwordx4 v4, v[120:123], s[56:57] offset:512 sc1
  v_cvt_pk_bf16_f32 v127, v59, v63
  v_and_b32 v127, s97, v127
  global_store_dwordx4 v4, v[124:127], s[56:57] offset:768 sc1
L_P2:
  s_add_u32 s38, s34, 24576
  s_addc_u32 s39, s35, 0
  v_lshl_add_u64 v[8:9], v[2:3], 0, s[38:39]
  s_barrier
  global_load_dwordx4 v[72:75], v[8:9], off
  s_add_u32 m0, s53, 38912
  s_add_u32 s53, s52, 72956
  buffer_load_dwordx4 v5, s[48:51], s52 offen lds
  buffer_load_dwordx4 v5, s[48:51], s53 offen offset:1028 lds
  s_setprio 0
  v_lshl_add_u32 v10, s3, 11, v2
  ds_read_b128 v[64:67], v10 offset:63488
  ds_read_b128 v[68:71], v10 offset:64512
  v_lshrrev_b32 v6, 3, v1
  v_mul_u32_u24 v6, 516, v6
  v_lshl_add_u32 v6, v1, 6, v6
  v_lshlrev_b32 v7, 3, v1
  v_and_b32 v7, 48, v7
  s_add_u32 s36, s54, 6
  s_and_b32 s36, s36, 63
  v_xad_u32 v77, v7, s54, v6
  v_xad_u32 v62, v7, s36, v6
  v_lshrrev_b32 v6, 4, v1
  v_bfe_u32 v76, v2, 1, 7
  s_mov_b32 s36, 655360
  v_mad_u32_u24 v76, v6, s36, v76
  v_lshlrev_b32 v78, v2, 1
  v_and_b32 v79, 1, v78
  v_mul_u32_u24 v79, s99, v79
  s_lshl_b32 s36, s3, 11
  s_add_u32 s38, s36, 25600
  s_add_u32 s38, s34, s38
  s_addc_u32 s39, s35, 0
  v_lshl_add_u64 v[60:61], v[2:3], 0, s[38:39]
  s_waitcnt lgkmcnt(1)
  v_pk_add_u16 v80, v64, s95 op_sel:[1,0] op_sel_hi:[0,1]
  v_pk_add_u16 v81, v65, s95 op_sel:[1,0] op_sel_hi:[0,1]
  v_pk_add_u16 v82, v66, s95 op_sel:[1,0] op_sel_hi:[0,1]
  v_pk_add_u16 v83, v67, s95 op_sel:[1,0] op_sel_hi:[0,1]
  s_waitcnt lgkmcnt(0)
  v_pk_add_u16 v84, v68, s95 op_sel:[1,0] op_sel_hi:[0,1]
  v_pk_add_u16 v85, v69, s95 op_sel:[1,0] op_sel_hi:[0,1]
  v_pk_add_u16 v86, v70, s95 op_sel:[1,0] op_sel_hi:[0,1]
  v_pk_add_u16 v87, v71, s95 op_sel:[1,0] op_sel_hi:[0,1]
  s_cmp_lt_u32 s2, 128
  s_cbranch_scc1 L_nosent
  s_cmp_lg_u32 s3, 0
  s_cbranch_scc1 L_nosent
  s_mov_b64 exec, 0xff
  global_load_dwordx2 v[8:9], v76, s[42:43] offset:0 sc1
L_ps_chk:
  s_waitcnt vmcnt(0)
  v_xor_b32 v6, v8, v78
  v_bitop3_b32 v6, v6, v9, v79 bitop3:0xf6
  v_and_b32 v6, s99, v6
  v_cmp_ne_u32 vcc, 0, v6
  s_nop 0
  s_cbranch_vccz L_ps_ok
  s_cmp_eq_u32 s96, 0
  s_cbranch_scc1 L_ps_ok
  s_sub_u32 s96, s96, 1
  s_sleep 2
  global_load_dwordx2 v[8:9], v76, s[42:43] offset:0 sc1
  s_branch L_ps_chk
L_ps_ok:
  s_mov_b64 exec, -1
L_nosent:
  s_waitcnt vmcnt(0)
  s_barrier
  global_load_dwordx2 v[8:9], v76, s[42:43] offset:0 sc1
  global_load_dwordx2 v[12:13], v76, s[42:43] offset:1024 sc1
  global_load_dwordx2 v[10:11], v76, s[42:43] offset:2048 sc1
  global_load_dwordx2 v[14:15], v76, s[42:43] offset:3072 sc1
  ds_read_u16_d16_hi v96, v77 offset:38912
  ds_read_u16_d16_hi v100, v77 offset:39424
  ds_read_u16_d16_hi v104, v77 offset:47136
  ds_read_u16_d16_hi v108, v77 offset:47648
  ds_read_u16_d16_hi v97, v77 offset:38914
  ds_read_u16_d16_hi v101, v77 offset:39426
  ds_read_u16_d16_hi v105, v77 offset:47138
  ds_read_u16_d16_hi v109, v77 offset:47650
  ds_read_u16_d16_hi v98, v77 offset:38916
  ds_read_u16_d16_hi v102, v77 offset:39428
  ds_read_u16_d16_hi v106, v77 offset:47140
  ds_read_u16_d16_hi v110, v77 offset:47652
  ds_read_u16_d16_hi v99, v62 offset:38912
  ds_read_u16_d16_hi v103, v62 offset:39424
  ds_read_u16_d16_hi v107, v62 offset:47136
  ds_read_u16_d16_hi v111, v62 offset:47648
  s_add_u32 s58, s36, 63488
  v_xor_b32_sdwa v92, s36, v75 dst_sel:DWORD dst_unused:UNUSED_PAD src0_sel:DWORD src1_sel:WORD_1
  s_and_b32 s37, s3, 3
  s_lshl_b32 s37, s37, 5
  s_or_b32 s36, s36, s37
  v_xor_b32_sdwa v89, s36, v74 dst_sel:DWORD dst_unused:UNUSED_PAD src0_sel:DWORD src1_sel:WORD_1
  s_lshl_b32 s36, s3, 6
  s_lshl_b32 s37, s3, 4
  v_xor_b32_sdwa v88, s36, v74 dst_sel:DWORD dst_unused:UNUSED_PAD src0_sel:DWORD src1_sel:WORD_0
  v_xor_b32_sdwa v91, s37, v75 dst_sel:DWORD dst_unused:UNUSED_PAD src0_sel:DWORD src1_sel:WORD_0
  v_xor_b32 v90, 16, v89
  v_xor_b32 v93, 0x120, v92
  v_xor_b32 v94, 64, v92
  v_xor_b32 v95, 64, v93
  s_cmp_lg_u32 s55, 0
  s_cbranch_scc1 L_now0
  s_waitcnt lgkmcnt(14)
  v_mul_f32 v96, 0.5, v96
  v_mul_f32 v100, 0.5, v100
  s_waitcnt lgkmcnt(13)
  v_mul_f32 v104, 0.5, v104
  s_waitcnt lgkmcnt(12)
  v_mul_f32 v108, 0.5, v108
L_now0:
  s_cmp_lg_u32 s55, 76
  s_cbranch_scc1 L_now2
  s_waitcnt lgkmcnt(7)
  v_mul_f32 v98, 0.5, v98
  s_waitcnt lgkmcnt(6)
  v_mul_f32 v102, 0.5, v102
  s_waitcnt lgkmcnt(5)
  v_mul_f32 v106, 0.5, v106
  s_waitcnt lgkmcnt(4)
  v_mul_f32 v110, 0.5, v110
L_now2:
  s_setprio 2
L_px_chk:
  s_waitcnt vmcnt(0)
  v_xor_b32 v6, v8, v78
  v_bitop3_b32 v6, v6, v9, v79 bitop3:0xf6
  v_bitop3_b32 v6, v6, v12, v78 bitop3:0xf6
  v_bitop3_b32 v6, v6, v13, v79 bitop3:0xf6
  v_bitop3_b32 v6, v6, v10, v78 bitop3:0xf6
  v_bitop3_b32 v6, v6, v11, v79 bitop3:0xf6
  v_bitop3_b32 v6, v6, v14, v78 bitop3:0xf6
  v_bitop3_b32 v6, v6, v15, v79 bitop3:0xf6
  v_and_b32 v6, s99, v6
  v_cmp_ne_u32 vcc, 0, v6
  s_nop 0
  s_cbranch_vccz L_px_ok
  s_cmp_eq_u32 s96, 0
  s_cbranch_scc1 L_px_ok
  s_sub_u32 s96, s96, 1
  s_sleep 1
  global_load_dwordx2 v[8:9], v76, s[42:43] offset:0 sc1
  global_load_dwordx2 v[12:13], v76, s[42:43] offset:1024 sc1
  global_load_dwordx2 v[10:11], v76, s[42:43] offset:2048 sc1
  global_load_dwordx2 v[14:15], v76, s[42:43] offset:3072 sc1
  s_branch L_px_chk
L_px_ok:
  s_mov_b32 m0, s58
  v_swap_b32 v9, v12
  v_swap_b32 v11, v14
  s_nop 1
  v_mfma_f32_16x16x32_bf16 v[16:19], v[64:67], v[8:11], 0
  v_mfma_f32_16x16x32_bf16 v[20:23], v[80:83], v[8:11], 0
  v_mfma_f32_16x16x32_bf16 v[24:27], v[64:67], v[12:15], 0
  v_mfma_f32_16x16x32_bf16 v[28:31], v[80:83], v[12:15], 0
  s_nop 4
  v_cvt_pk_bf16_f32 v32, v16, v17
  v_cvt_pk_bf16_f32 v33, v18, v19
  v_cvt_pk_bf16_f32 v34, v20, v21
  v_cvt_pk_bf16_f32 v35, v22, v23
  ds_write_b128 v88, v[32:35] offset:20480
  v_cvt_pk_bf16_f32 v36, v24, v25
  v_cvt_pk_bf16_f32 v37, v26, v27
  v_cvt_pk_bf16_f32 v38, v28, v29
  v_cvt_pk_bf16_f32 v39, v30, v31
  ds_write_b128 v88, v[36:39] offset:20992
  s_waitcnt vmcnt(0) lgkmcnt(0)
  s_barrier
  ds_read_b64_tr_b16 v[8:9], v89 offset:20480
  ds_read_b64_tr_b16 v[10:11], v89 offset:20992
  ds_read_b64_tr_b16 v[12:13], v90 offset:21504
  ds_read_b64_tr_b16 v[14:15], v90 offset:22016
  global_load_lds_dwordx4 v[60:61], off
  global_load_lds_dwordx4 v[60:61], off offset:1024
  s_waitcnt lgkmcnt(3)
  v_mfma_f32_16x16x16_bf16 v[16:19], v[72:73], v[8:9], 0
  s_waitcnt lgkmcnt(2)
  v_mfma_f32_16x16x16_bf16 v[20:23], v[72:73], v[10:11], 0
  s_waitcnt lgkmcnt(1)
  v_mfma_f32_16x16x16_bf16 v[24:27], v[72:73], v[12:13], 0
  s_waitcnt lgkmcnt(0)
  v_mfma_f32_16x16x16_bf16 v[28:31], v[72:73], v[14:15], 0
  s_nop 1
  v_mul_f32 v6, v16, v96
  v_mul_f32 v7, v18, v100
  v_fma_f32 v6, -v17, v104, v6
  v_fma_f32 v7, -v19, v108, v7
  v_mul_f32 v17, v17, v96
  v_mul_f32 v19, v19, v100
  v_fmac_f32 v17, v16, v104
  v_fmac_f32 v19, v18, v108
  v_cvt_pk_bf16_f32 v8, v6, -v17
  v_cvt_pk_bf16_f32 v9, v7, -v19
  v_mul_f32 v6, v20, v97
  v_mul_f32 v7, v22, v101
  v_mfma_f32_16x16x16_bf16 v[32:35], v[72:73], v[8:9], 0
  v_fma_f32 v6, -v21, v105, v6
  v_fma_f32 v7, -v23, v109, v7
  v_mul_f32 v21, v21, v97
  v_mul_f32 v23, v23, v101
  v_fmac_f32 v21, v20, v105
  v_fmac_f32 v23, v22, v109
  v_cvt_pk_bf16_f32 v10, v6, -v21
  v_cvt_pk_bf16_f32 v11, v7, -v23
  v_mul_f32 v6, v24, v98
  v_mul_f32 v7, v26, v102
  v_mfma_f32_16x16x16_bf16 v[36:39], v[72:73], v[10:11], 0
  v_fma_f32 v6, -v25, v106, v6
  v_fma_f32 v7, -v27, v110, v7
  v_mul_f32 v25, v25, v98
  v_mul_f32 v27, v27, v102
  v_fmac_f32 v25, v24, v106
  v_fmac_f32 v27, v26, v110
  v_cvt_pk_bf16_f32 v12, v6, -v25
  v_cvt_pk_bf16_f32 v13, v7, -v27
  v_mul_f32 v6, v28, v99
  v_mul_f32 v7, v30, v103
  v_mfma_f32_16x16x16_bf16 v[40:43], v[72:73], v[12:13], 0
  v_fma_f32 v6, -v29, v107, v6
  v_fma_f32 v7, -v31, v111, v7
  v_mul_f32 v29, v29, v99
  v_mul_f32 v31, v31, v103
  v_fmac_f32 v29, v28, v107
  v_fmac_f32 v31, v30, v111
  v_cvt_pk_bf16_f32 v14, v6, -v29
  v_cvt_pk_bf16_f32 v15, v7, -v31
  v_cvt_pk_bf16_f32 v48, v32, v36
  v_cvt_pk_bf16_f32 v50, v33, v37
  v_mfma_f32_16x16x16_bf16 v[44:47], v[72:73], v[14:15], 0
  v_cvt_pk_bf16_f32 v52, v34, v38
  v_cvt_pk_bf16_f32 v54, v35, v39
  s_nop 5
  v_cvt_pk_bf16_f32 v49, v40, v44
  v_cvt_pk_bf16_f32 v51, v41, v45
  ds_write_b128 v91, v[48:51] offset:0
  v_cvt_pk_bf16_f32 v53, v42, v46
  v_cvt_pk_bf16_f32 v55, v43, v47
  ds_write_b128 v91, v[52:55] offset:2048
  s_waitcnt vmcnt(0) lgkmcnt(0)
  s_barrier
  ds_read_b64_tr_b16 v[8:9], v92 offset:0
  ds_read_b64_tr_b16 v[10:11], v93 offset:0
  ds_read_b64_tr_b16 v[12:13], v94 offset:0
  ds_read_b64_tr_b16 v[14:15], v95 offset:0
  s_waitcnt lgkmcnt(2)
  v_mfma_f32_16x16x32_bf16 v[16:19], v[68:71], v[8:11], 0
  v_mfma_f32_16x16x32_bf16 v[20:23], v[84:87], v[8:11], 0
  s_waitcnt lgkmcnt(0)
  v_mfma_f32_16x16x32_bf16 v[24:27], v[68:71], v[12:15], 0
  v_mfma_f32_16x16x32_bf16 v[28:31], v[84:87], v[12:15], 0
  s_nop 4
  v_cvt_pk_bf16_f32 v32, v16, v20
  v_bitop3_b32 v32, v32, v78, s99 bitop3:0x72
  v_cvt_pk_bf16_f32 v34, v17, v21
  v_bitop3_b32 v34, v34, v78, s99 bitop3:0x72
  v_cvt_pk_bf16_f32 v36, v18, v22
  v_bitop3_b32 v36, v36, v78, s99 bitop3:0x72
  v_cvt_pk_bf16_f32 v38, v19, v23
  v_bitop3_b32 v38, v38, v78, s99 bitop3:0x72
  v_cvt_pk_bf16_f32 v33, v24, v28
  v_bitop3_b32 v33, v33, v79, s99 bitop3:0x72
  global_store_dwordx2 v76, v[32:33], s[42:43] offset:0 sc1
  v_cvt_pk_bf16_f32 v35, v25, v29
  v_bitop3_b32 v35, v35, v79, s99 bitop3:0x72
  global_store_dwordx2 v76, v[34:35], s[42:43] offset:1024 sc1
  v_cvt_pk_bf16_f32 v37, v26, v30
  v_bitop3_b32 v37, v37, v79, s99 bitop3:0x72
  global_store_dwordx2 v76, v[36:37], s[42:43] offset:2048 sc1
  v_cvt_pk_bf16_f32 v39, v27, v31
  v_bitop3_b32 v39, v39, v79, s99 bitop3:0x72
  global_store_dwordx2 v76, v[38:39], s[42:43] offset:3072 sc1
  s_cmp_ge_u32 s2, 128
  s_cbranch_scc1 L_end
  s_setprio 0
  v_mov_b32 v1, v4
  ds_read_b128 v[4:7], v2 offset:62464
  v_add_u32 v8, 63488, v2
  ds_read_b128 v[64:67], v8 offset:0
  ds_read_b128 v[68:71], v8 offset:1024
  ds_read_b128 v[72:75], v8 offset:2048
  ds_read_b128 v[76:79], v8 offset:3072
  ds_read_b128 v[80:83], v8 offset:4096
  ds_read_b128 v[84:87], v8 offset:5120
  ds_read_b128 v[88:91], v8 offset:6144
  ds_read_b128 v[92:95], v8 offset:7168
  ds_read_b128 v[96:99], v8 offset:8192
  ds_read_b128 v[100:103], v8 offset:9216
  ds_read_b128 v[104:107], v8 offset:10240
  ds_read_b128 v[108:111], v8 offset:11264
  ds_read_b128 v[112:115], v8 offset:12288
  ds_read_b128 v[116:119], v8 offset:13312
  ds_read_b128 v[120:123], v8 offset:14336
  ds_read_b128 v[124:127], v8 offset:15360
  s_lshl_b32 s36, s3, 3
  s_waitcnt lgkmcnt(14)
  v_xor_b32_sdwa v58, s36, v64 dst_sel:DWORD dst_unused:UNUSED_PAD src0_sel:DWORD src1_sel:WORD_0
  v_xor_b32_sdwa v59, s36, v64 dst_sel:DWORD dst_unused:UNUSED_PAD src0_sel:DWORD src1_sel:WORD_1
  v_xor_b32_sdwa v60, s36, v65 dst_sel:DWORD dst_unused:UNUSED_PAD src0_sel:DWORD src1_sel:WORD_0
  v_xor_b32_sdwa v61, s36, v65 dst_sel:DWORD dst_unused:UNUSED_PAD src0_sel:DWORD src1_sel:WORD_1
  v_xor_b32_sdwa v62, s36, v66 dst_sel:DWORD dst_unused:UNUSED_PAD src0_sel:DWORD src1_sel:WORD_0
  v_xor_b32_sdwa v63, s36, v66 dst_sel:DWORD dst_unused:UNUSED_PAD src0_sel:DWORD src1_sel:WORD_1
  v_add_u32_sdwa v56, s40, v67 dst_sel:DWORD dst_unused:UNUSED_PAD src0_sel:DWORD src1_sel:WORD_0
  v_add_u32_sdwa v57, s40, v67 dst_sel:DWORD dst_unused:UNUSED_PAD src0_sel:DWORD src1_sel:WORD_1
  ds_read_b128 v[64:67], v2 offset:61440
  s_cmp_ge_u32 s3, 5
  s_waitcnt vmcnt(0) lgkmcnt(0)
  s_setprio 3
  s_barrier
  s_cbranch_scc1 L_z1
  global_load_dwordx4 v[8:11], v1, s[56:57] offset:0 sc1
  global_load_dwordx4 v[12:15], v1, s[56:57] offset:256 sc1
  global_load_dwordx4 v[16:19], v1, s[56:57] offset:512 sc1
  global_load_dwordx4 v[20:23], v1, s[56:57] offset:768 sc1
L_pz_chk:
  s_waitcnt vmcnt(0)
  v_bitop3_b32 v24, v10, v8, 1 bitop3:0xdb
  v_bitop3_b32 v24, v24, v11, v9 bitop3:0xfb
  v_bitop3_b32 v25, v14, v12, 1 bitop3:0xdb
  v_bitop3_b32 v25, v25, v15, v13 bitop3:0xfb
  v_or_b32 v24, v24, v25
  v_bitop3_b32 v25, v18, v16, 1 bitop3:0xdb
  v_bitop3_b32 v25, v25, v19, v17 bitop3:0xfb
  v_or_b32 v24, v24, v25
  v_bitop3_b32 v25, v22, v20, 1 bitop3:0xdb
  v_bitop3_b32 v25, v25, v23, v21 bitop3:0xfb
  v_bitop3_b32 v24, v24, v25, s99 bitop3:0xa8
  v_cmp_ne_u32 vcc, 0, v24
  s_nop 0
  s_cbranch_vccz L_pz_ok
  s_cmp_eq_u32 s96, 0
  s_cbranch_scc1 L_pz_ok
  s_sub_u32 s96, s96, 1
  s_wqm_b64 exec, vcc
  s_sleep 1
  global_load_dwordx4 v[8:11], v1, s[56:57] offset:0 sc1
  global_load_dwordx4 v[12:15], v1, s[56:57] offset:256 sc1
  global_load_dwordx4 v[16:19], v1, s[56:57] offset:512 sc1
  global_load_dwordx4 v[20:23], v1, s[56:57] offset:768 sc1
  s_branch L_pz_chk
L_pz_ok:
  s_mov_b64 exec, -1
  v_swap_b32 v9, v12
  v_swap_b32 v10, v16
  v_swap_b32 v11, v20
  v_swap_b32 v14, v17
  s_nop 0
  v_mfma_f32_16x16x32_bf16 v[24:27], v[64:67], v[8:11], 0
  v_mfma_f32_16x16x32_bf16 v[28:31], v[4:7], v[8:11], 0
  v_swap_b32 v15, v21
  v_swap_b32 v19, v22
  s_nop 0
  v_mfma_f32_16x16x32_bf16 v[32:35], v[64:67], v[12:15], 0
  v_mfma_f32_16x16x32_bf16 v[36:39], v[4:7], v[12:15], 0
  v_mfma_f32_16x16x32_bf16 v[40:43], v[64:67], v[16:19], 0
  v_mfma_f32_16x16x32_bf16 v[44:47], v[4:7], v[16:19], 0
  v_mfma_f32_16x16x32_bf16 v[48:51], v[64:67], v[20:23], 0
  v_mfma_f32_16x16x32_bf16 v[52:55], v[4:7], v[20:23], 0
  v_cvt_pk_bf16_f32 v8, v24, v28
  v_cvt_pk_bf16_f32 v9, v25, v29
  v_cvt_pk_bf16_f32 v10, v26, v30
  v_cvt_pk_bf16_f32 v11, v27, v31
  ds_write_b128 v0, v[8:11] offset:0
  v_cvt_pk_bf16_f32 v12, v32, v36
  v_cvt_pk_bf16_f32 v13, v33, v37
  v_cvt_pk_bf16_f32 v14, v34, v38
  v_cvt_pk_bf16_f32 v15, v35, v39
  v_xor_b32 v0, 16, v0
  ds_write_b128 v0, v[12:15] offset:5120
  v_cvt_pk_bf16_f32 v16, v40, v44
  v_cvt_pk_bf16_f32 v17, v41, v45
  v_cvt_pk_bf16_f32 v18, v42, v46
  v_cvt_pk_bf16_f32 v19, v43, v47
  v_xor_b32 v0, 48, v0
  ds_write_b128 v0, v[16:19] offset:10240
  v_cvt_pk_bf16_f32 v20, v48, v52
  v_cvt_pk_bf16_f32 v21, v49, v53
  v_cvt_pk_bf16_f32 v22, v50, v54
  v_cvt_pk_bf16_f32 v23, v51, v55
  v_xor_b32 v0, 16, v0
  ds_write_b128 v0, v[20:23] offset:15360
L_z1:
  s_waitcnt lgkmcnt(0)
  s_barrier
  ds_read_b64 v[20:21], v58
  ds_read_b64 v[24:25], v59
  ds_read_b64 v[22:23], v60
  ds_read_b64 v[26:27], v61
  ds_read_b64 v[28:29], v62
  ds_read_b64 v[30:31], v63
  v_add_u32 v5, 293760, v2
  v_add_u32 v1, s40, v2
  v_cndmask_b32 v4, v5, v2, s[44:45]
  s_waitcnt lgkmcnt(4)
  v_swap_b32 v21, v24
  s_waitcnt lgkmcnt(2)
  v_swap_b32 v23, v26
  s_waitcnt lgkmcnt(0)
  v_swap_b32 v29, v30
  v_mfma_f32_16x16x32_bf16 v[32:35], v[20:23], v[68:71], 0
  v_mfma_f32_16x16x32_bf16 v[36:39], v[20:23], v[72:75], 0
  v_mfma_f32_16x16x16_bf16 v[32:35], v[28:29], v[76:77], v[32:35]
  v_mfma_f32_16x16x16_bf16 v[36:39], v[28:29], v[78:79], v[36:39]
  v_mfma_f32_16x16x32_bf16 v[40:43], v[24:27], v[68:71], 0
  v_mfma_f32_16x16x32_bf16 v[44:47], v[24:27], v[72:75], 0
  v_mfma_f32_16x16x16_bf16 v[40:43], v[30:31], v[76:77], v[40:43]
  v_mfma_f32_16x16x16_bf16 v[44:47], v[30:31], v[78:79], v[44:47]
  v_mfma_f32_16x16x32_bf16 v[48:51], v[20:23], v[80:83], 0
  s_nop 1
  v_mul_f32 v6, v32, v104
  v_mul_f32 v7, v33, v105
  v_fmac_f32 v6, v36, v108
  v_mfma_f32_16x16x32_bf16 v[52:55], v[20:23], v[84:87], 0
  v_fmac_f32 v7, v37, v109
  v_mul_f32 v36, v36, v104
  v_mul_f32 v37, v37, v105
  v_mfma_f32_16x16x32_bf16 v[48:51], v[24:27], v[92:95], v[48:51]
  v_fma_f32 v36, -v32, v108, v36
  v_fma_f32 v37, -v33, v109, v37
  v_cvt_pk_bf16_f32 v8, v6, v36
  v_cvt_pk_bf16_f32 v9, v7, v37
  v_mfma_f32_16x16x32_bf16 v[52:55], v[24:27], v[96:99], v[52:55]
  v_mul_f32 v6, v34, v106
  v_mul_f32 v7, v35, v107
  v_fmac_f32 v6, v38, v110
  v_mfma_f32_16x16x32_bf16 v[48:51], v[28:31], v[88:91], v[48:51]
  v_fmac_f32 v7, v39, v111
  v_mul_f32 v38, v38, v106
  v_mul_f32 v39, v39, v107
  v_mfma_f32_16x16x32_bf16 v[52:55], v[28:31], v[100:103], v[52:55]
  v_fma_f32 v38, -v34, v110, v38
  v_fma_f32 v39, -v35, v111, v39
  v_cvt_pk_bf16_f32 v10, v6, v38
  v_cvt_pk_bf16_f32 v11, v7, v39
  s_nop 1
  v_mfma_f32_16x16x32_bf16 v[20:23], v[8:11], v[120:123], 0
  v_mul_f32 v6, v40, v104
  v_mul_f32 v7, v41, v105
  v_fmac_f32 v6, v44, v108
  v_fmac_f32 v7, v45, v109
  v_mul_f32 v44, v44, v104
  v_mul_f32 v45, v45, v105
  v_fma_f32 v44, -v40, v108, v44
  v_fma_f32 v45, -v41, v109, v45
  v_cvt_pk_bf16_f32 v12, v6, v44
  v_cvt_pk_bf16_f32 v13, v7, v45
  v_mfma_f32_16x16x32_bf16 v[24:27], v[8:11], v[124:127], 0
  v_mul_f32 v6, v42, v106
  v_mul_f32 v7, v43, v107
  v_fmac_f32 v6, v46, v110
  v_fmac_f32 v7, v47, v111
  v_mul_f32 v46, v46, v106
  v_mul_f32 v47, v47, v107
  v_fma_f32 v46, -v42, v110, v46
  v_fma_f32 v47, -v43, v111, v47
  v_cvt_pk_bf16_f32 v14, v6, v46
  v_cvt_pk_bf16_f32 v15, v7, v47
  s_nop 1
  v_mfma_f32_16x16x32_bf16 v[32:35], v[12:15], v[120:123], 0
  v_mul_f32 v6, v48, v112
  v_mul_f32 v7, v49, v113
  v_fmac_f32 v6, v52, v116
  v_fmac_f32 v7, v53, v117
  v_mul_f32 v52, v52, v112
  v_mul_f32 v53, v53, v113
  v_fma_f32 v52, -v48, v116, v52
  v_fma_f32 v53, -v49, v117, v53
  v_cvt_pk_bf16_f32 v16, v6, v52
  v_cvt_pk_bf16_f32 v17, v7, v53
  v_mfma_f32_16x16x32_bf16 v[36:39], v[12:15], v[124:127], 0
  v_mul_f32 v6, v50, v114
  v_mul_f32 v7, v51, v115
  v_fmac_f32 v6, v54, v118
  v_fmac_f32 v7, v55, v119
  v_mul_f32 v54, v54, v114
  v_mul_f32 v55, v55, v115
  v_fma_f32 v54, -v50, v118, v54
  v_fma_f32 v55, -v51, v119, v55
  v_cvt_pk_bf16_f32 v18, v6, v54
  v_cvt_pk_bf16_f32 v19, v7, v55
  s_nop 1
  v_mfma_f32_16x16x32_bf16 v[40:43], v[16:19], v[120:123], 0
  v_mfma_f32_16x16x32_bf16 v[44:47], v[16:19], v[124:127], 0
  v_cvt_pk_bf16_f32 v20, v20, v21
  v_cvt_pk_bf16_f32 v21, v22, v23
  ds_write_b64 v56, v[20:21] offset:0
  v_cvt_pk_bf16_f32 v32, v32, v33
  v_cvt_pk_bf16_f32 v33, v34, v35
  ds_write_b64 v56, v[32:33] offset:1152
  v_cvt_pk_bf16_f32 v24, v24, v25
  v_cvt_pk_bf16_f32 v25, v26, v27
  v_cvt_pk_bf16_f32 v36, v36, v37
  v_cvt_pk_bf16_f32 v37, v38, v39
  v_cvt_pk_bf16_f32 v40, v40, v41
  v_cvt_pk_bf16_f32 v41, v42, v43
  ds_write_b64 v57, v[40:41] offset:32
  v_cvt_pk_bf16_f32 v44, v44, v45
  v_cvt_pk_bf16_f32 v45, v46, v47
  s_mov_b32 exec_lo, 0x00ff00ff
  s_mov_b32 exec_hi, 0x00ff00ff
  ds_write_b64 v56, v[24:25] offset:768
  ds_write_b64 v56, v[36:37] offset:1920
  ds_write_b64 v57, v[44:45] offset:800
  s_mov_b64 exec, -1
  ds_read_b128 v[8:11], v1 offset:0
  ds_read_b128 v[12:15], v1 offset:1024
  ds_read_b128 v[16:19], v1 offset:2048
  s_waitcnt lgkmcnt(2)
  global_store_dwordx4 v2, v[8:11], s[28:29] sc1
  s_waitcnt lgkmcnt(1)
  global_store_dwordx4 v4, v[12:15], s[28:29] offset:1024 sc1
  s_mov_b64 exec, 0xffff
  s_waitcnt lgkmcnt(0)
  global_store_dwordx4 v5, v[16:19], s[28:29] offset:2048 sc1
L_end:
  s_endpgm
L_aux3:
  s_waitcnt lgkmcnt(0)
  s_cmp_eq_u32 s59, 0
  s_cbranch_scc1 L_auxB
  s_waitcnt vmcnt(1)
  s_cmp_ge_u32 s3, 4
  s_cbranch_scc1 L_A0a
  s_waitcnt vmcnt(0)
L_A0a:
  ds_write_b128 v120, v[124:127] offset:35712
  s_waitcnt lgkmcnt(0)
  s_barrier
  ds_read_u16 v96, v121 offset:35712
  ds_read_u16 v97, v121 offset:35840
  ds_read_u16 v98, v121 offset:35968
  ds_read_u16 v99, v121 offset:36096
  ds_read_u16 v100, v121 offset:36224
  ds_read_u16 v101, v121 offset:36352
  ds_read_u16 v102, v121 offset:36480
  ds_read_u16 v103, v121 offset:36608
  s_waitcnt lgkmcnt(6)
  v_lshl_or_b32 v96, v97, 16, v96
  s_waitcnt lgkmcnt(4)
  v_lshl_or_b32 v97, v99, 16, v98
  s_waitcnt lgkmcnt(2)
  v_lshl_or_b32 v98, v101, 16, v100
  s_waitcnt lgkmcnt(0)
  v_lshl_or_b32 v99, v103, 16, v102
  v_bitop3_b32 v96, v96, s97, 1 bitop3:0xea
  v_or_b32 v97, s99, v97
  v_bitop3_b32 v98, v98, -2, s98 bitop3:0xea
  v_and_b32 v99, s97, v99
  global_store_dwordx4 v122, v[96:99], s[60:61] sc1
  s_waitcnt vmcnt(0)
  s_mov_b64 exec, 15
  global_load_dwordx4 v[8:11], v122, s[60:61] sc1
L_p0_chk:
  s_waitcnt vmcnt(0)
  v_bitop3_b32 v12, v10, v8, 1 bitop3:0xdb
  v_bitop3_b32 v12, v12, v11, v9 bitop3:0xfb
  v_and_b32 v12, s99, v12
  v_cmp_ne_u32 vcc, 0, v12
  s_nop 0
  s_cbranch_vccz L_p0_ok
  s_cmp_eq_u32 s96, 0
  s_cbranch_scc1 L_p0_ok
  s_sub_u32 s96, s96, 1
  s_wqm_b64 exec, vcc
  s_sleep 8
  global_load_dwordx4 v[8:11], v122, s[60:61] sc1
  s_branch L_p0_chk
L_p0_ok:
  s_mov_b64 exec, -1
  s_branch L_tile_out
L_auxB:
  s_mov_b64 s[56:57], s[32:33]
  v_mov_b32 v4, 0
  v_and_b32 v8, 0xf0, v2
  v_lshrrev_b32 v9, 4, v1
  v_cvt_f32_u32 v8, v8
  v_cvt_f32_u32 v9, v9
  v_cvt_f32_u32 v10, s3
  v_mul_f32 v8, 0x3b800000, v8
  v_mul_f32 v9, 4.0, v9
  v_mul_f32 v10, 0x3e000000, v10
  v_add_f32 v11, v9, v10
  v_mul_f32 v11, v11, v8
  v_cos_f32 v20, v11
  v_sin_f32 v21, v11
  v_add_f32 v11, v11, v8
  v_cvt_pk_bf16_f32 v12, v20, v21
  v_cos_f32 v20, v11
  v_sin_f32 v21, v11
  v_add_f32 v11, v11, v8
  v_cvt_pk_bf16_f32 v13, v20, v21
  v_cos_f32 v20, v11
  v_sin_f32 v21, v11
  v_add_f32 v11, v11, v8
  v_cvt_pk_bf16_f32 v14, v20, v21
  v_cos_f32 v20, v11
  v_sin_f32 v21, v11
  s_nop 0
  v_cvt_pk_bf16_f32 v15, v20, v21
  v_lshl_add_u32 v23, s3, 11, v2
  ds_write_b128 v23, v[12:15] offset:63488
  v_fmamk_f32 v10, v10, 0x3d800000, v8
  v_mul_f32 v11, v9, v10
  v_cos_f32 v20, v11
  v_sin_f32 v21, v11
  v_add_f32 v11, v11, v10
  v_cvt_pk_bf16_f32 v16, v20, v21
  v_cos_f32 v20, v11
  v_sin_f32 v21, v11
  v_add_f32 v11, v11, v10
  v_cvt_pk_bf16_f32 v17, v20, v21
  v_cos_f32 v20, v11
  v_sin_f32 v21, v11
  v_add_f32 v11, v11, v10
  v_cvt_pk_bf16_f32 v18, v20, v21
  v_cos_f32 v20, v11
  v_sin_f32 v21, v11
  s_nop 0
  v_cvt_pk_bf16_f32 v19, v20, v21
  ds_write_b128 v23, v[16:19] offset:64512
  s_and_b32 s46, s2, 15
  s_lshr_b32 s47, s2, 4
  s_and_b32 s36, s3, 3
  s_lshl_b32 s36, s36, 9
  s_add_u32 s36, s36, s46
  s_mul_i32 s36, s36, 578
  s_and_b32 s54, s36, 2
  s_sub_u32 s36, s36, s54
  s_lshl3_add_u32 s54, s3, s54
  s_mul_i32 s37, s47, 60
  s_add_u32 s52, s36, s37
  v_lshrrev_b32 v5, 2, v1
  v_and_b32 v6, 8, v5
  v_add_u32 v5, v5, v6
  v_lshlrev_b32 v6, 1, v1
  v_xor_b32 v6, v6, v2
  v_and_b32 v6, 48, v6
  s_mul_i32 s53, s3, 2056
  s_movk_i32 s36, 9248
  v_mad_u32_u24 v5, v5, s36, v6
  s_cmp_lt_u32 s3, 4
  s_cselect_b64 s[48:49], s[24:25], s[26:27]
  s_mov_b32 s50, 1183744
  s_mov_b32 s51, 0x20000
  s_bfe_u32 s36, s2, 0x20002
  s_lshl2_add_u32 s36, s3, s36
  s_mul_i32 s36, s36, 5
  s_lshr_b32 s37, s2, 5
  s_add_u32 s36, s36, s37
  s_and_b32 s37, s2, 3
  s_lshl4_add_u32 s36, s36, s37
  s_and_b32 s37, s47, 1
  s_lshl1_add_u32 s36, s36, s37
  s_lshl_b32 s36, s36, 7
  s_add_u32 s42, s32, s36
  s_addc_u32 s43, s33, 0
  s_lshl3_add_u32 s55, s47, s3
  s_waitcnt vmcnt(0) lgkmcnt(0)
  s_branch L_P2
L_A1b:
  s_setprio 0
  s_mov_b32 s59, 0
  s_waitcnt vmcnt(4)
  global_load_ushort v124, v16, s[10:11]
  s_branch L_A_t0
L_A2b:
  s_setprio 1
  s_cmp_lt_u32 s2, 384
  s_cselect_b32 s59, 1, 2
  v_lshl_or_b32 v122, v18, 12, v19
  s_add_u32 s36, s45, s46
  s_add_u32 s28, s28, s36
  s_addc_u32 s29, s29, 0
  s_add_u32 s20, s20, s44
  s_addc_u32 s21, s21, 0
  s_lshl_b32 s36, s58, 18
  s_lshl_b32 s37, s57, 7
  s_add_u32 s36, s36, s37
  s_add_u32 s36, s36, 2621440
  s_add_u32 s60, s32, s36
  s_addc_u32 s61, s33, 0
  s_lshl_b32 s36, s3, 4
  v_xor_b32 v120, s36, v2
  v_xor_b32 v121, s36, v19
  v_lshl_add_u32 v121, v19, 6, v121
  v_lshrrev_b32 v18, 3, v1
  v_lshl_add_u32 v121, v18, 1, v121
  v_bfe_u32 v18, v1, 2, 1
  s_mov_b32 s37, 36864
  v_mad_u32_u24 v121, v18, s37, v121
  s_lshr_b32 s36, s3, 2
  s_mul_i32 s36, s36, s37
  s_lshl_b32 s37, s3, 10
  s_add_u32 s36, s36, s37
  v_add_u32 v120, s36, v120
L_A_t0:
  s_and_b32 s46, s3, 3
  s_lshl_b32 s53, s46, 10
  s_add_u32 s38, s53, 16384
  s_add_u32 s38, s34, s38
  s_addc_u32 s39, s35, 0
  v_lshl_add_u64 v[18:19], v[2:3], 0, s[38:39]
  global_load_dwordx4 v[88:91], v[18:19], off
  s_add_u32 s38, s34, 20480
  s_addc_u32 s39, s35, 0
  v_lshl_add_u64 v[86:87], v[2:3], 0, s[38:39]
  s_lshr_b32 s47, s3, 2
  s_mul_i32 s48, s47, 40960
  s_and_b32 s36, s46, 1
  s_lshl_b32 s36, s36, 8
  s_add_u32 m0, s48, s36
  s_cmp_lt_u32 s46, 2
  s_cselect_b32 s50, 1.0, 2.0
  s_mov_b32 s51, 0x43800000
  s_cselect_b32 s51, 0x41800000, s51
  s_mov_b32 s52, 0x3fb8aa3b
  s_lshl_b32 s36, s62, 12
  s_add_u32 s36, s36, s53
  s_add_u32 s36, s36, 2621440
  s_add_u32 s40, s32, s36
  s_addc_u32 s41, s33, 0
  s_cmp_eq_u32 s46, 1
  s_cselect_b32 s42, 0, -1
  s_cselect_b32 s43, 0xffffff00, -1
  s_add_u32 s36, s53, s48
  v_add_u32 v11, s36, v2
  s_lshl2_add_u32 s36, s53, s48
  v_add_u32 v9, s36, v2
  v_and_b32 v12, 0x100, v2
  v_lshrrev_b32 v16, 1, v2
  v_and_b32 v16, 0x100, v16
  v_sub_u32 v12, v12, v16
  v_add_u32 v12, v12, v2
  s_mov_b32 s44, 0
  s_mov_b32 s45, 0
  s_cmp_lg_u32 s46, 3
  s_cbranch_scc1 L_A_nz
  s_brev_b32 s45, 1
  v_mov_b32 v20, 0
  v_mov_b32 v21, 0
  v_mov_b32 v22, 0
  v_mov_b32 v23, 0
  s_mov_b64 exec, 0x7fffff
  ds_write_b128 v11, v[20:23] offset:29568
  s_mov_b64 exec, -1
L_A_nz:
  s_waitcnt lgkmcnt(0)
  s_and_b32 s36, s62, 1
  s_lshl_b32 s36, s36, 4
  s_lshr_b32 s63, s63, s36
  s_lshl_b32 s63, s63, 16
  v_mov_b32 v49, s52
  v_mul_f32 v49, s63, v49
  v_exp_f32 v49, v49
  s_nop 0
  v_cvt_pk_bf16_f32 v49, v49, v49
  v_and_b32 v49, 0xffff0000, v49
  v_add_f32 v48, v49, v49
  s_cmp_lg_u32 s59, 1
  s_cbranch_scc1 L_A_nt2
  s_setprio 3
  s_waitcnt vmcnt(0)
  ds_write_b128 v120, v[124:127] offset:35712
  s_waitcnt lgkmcnt(0)
  s_barrier
  ds_read_u16 v96, v121 offset:35712
  ds_read_u16 v97, v121 offset:35840
  ds_read_u16 v98, v121 offset:35968
  ds_read_u16 v99, v121 offset:36096
  ds_read_u16 v100, v121 offset:36224
  ds_read_u16 v101, v121 offset:36352
  ds_read_u16 v102, v121 offset:36480
  ds_read_u16 v103, v121 offset:36608
  s_waitcnt lgkmcnt(6)
  v_lshl_or_b32 v96, v97, 16, v96
  s_waitcnt lgkmcnt(4)
  v_lshl_or_b32 v97, v99, 16, v98
  s_waitcnt lgkmcnt(2)
  v_lshl_or_b32 v98, v101, 16, v100
  s_waitcnt lgkmcnt(0)
  v_lshl_or_b32 v99, v103, 16, v102
  v_bitop3_b32 v96, v96, s97, 1 bitop3:0xea
  v_or_b32 v97, s99, v97
  v_bitop3_b32 v98, v98, -2, s98 bitop3:0xea
  v_and_b32 v99, s97, v99
  global_store_dwordx4 v122, v[96:99], s[60:61] sc1
  s_setprio 1
  global_load_dwordx4 v[104:107], v[86:87], off
  global_load_dwordx4 v[108:111], v[86:87], off offset:1024
  global_load_dwordx4 v[112:115], v[86:87], off offset:2048
  global_load_dwordx4 v[116:119], v[86:87], off offset:3072
  s_branch L_A_nt3
L_A_nt2:
  s_waitcnt vmcnt(2)
L_A_nt3:
  v_lshlrev_b32 v50, 16, v50
  v_lshlrev_b32 v51, 16, v51
  v_lshlrev_b32 v52, 16, v52
  v_lshlrev_b32 v53, 16, v53
  v_mul_f32 v50, s52, v50
  v_exp_f32 v50, v50
  v_mul_f32 v51, v51, v49
  v_cvt_pk_bf16_f32 v50, v50, v50
  v_mul_f32 v51, 0.15915494, v51
  v_and_b32 v50, 0xffff0000, v50
  v_mul_f32 v50, v50, v49
  v_mul_f32 v59, s50, v51
  v_mul_f32 v61, s51, v51
  v_mul_f32 v50, s52, v50
  v_fract_f32 v59, v59
  v_fract_f32 v61, v61
  v_mul_f32 v58, s50, v50
  v_mul_f32 v60, s51, v50
  v_cos_f32 v54, v59
  v_sin_f32 v55, v59
  v_exp_f32 v58, -v58
  v_mul_f32 v52, v52, v48
  v_exp_f32 v60, -v60
  v_mul_f32 v53, v53, v48
  v_cos_f32 v56, v61
  v_mul_f32 v54, v54, v58
  v_sin_f32 v57, v61
  v_mul_f32 v55, v55, v58
  v_mul_f32 v56, v56, v60
  v_mul_f32 v57, v57, v60
  s_cmp_ge_u32 s46, 2
  s_cbranch_scc1 L_kg1a
  v_xor_b32 v57, 0x80000000, v57
  v_mov_b32 v20, v56
  v_mov_b32 v21, v57
  v_cvt_pk_bf16_f32 v40, v52, v53
  v_cvt_pk_bf16_f32 v41, v20, v21
  v_pk_mul_f32 v[22:23], v[52:53], v[54:55] op_sel_hi:[0,1]
  v_pk_mul_f32 v[24:25], v[20:21], v[56:57] op_sel_hi:[0,1]
  ds_write_addtid_b32 v40 offset:1024
  ds_write_addtid_b32 v41 offset:4128
  v_pk_fma_f32 v[52:53], v[52:53], v[54:55], v[22:23] op_sel:[1,1,0] op_sel_hi:[1,0,1] neg_lo:[1,0,0]
  v_pk_fma_f32 v[20:21], v[20:21], v[56:57], v[24:25] op_sel:[1,1,0] op_sel_hi:[1,0,1] neg_lo:[1,0,0]
  v_cvt_pk_bf16_f32 v42, v52, v53
  v_cvt_pk_bf16_f32 v43, v20, v21
  v_pk_mul_f32 v[22:23], v[52:53], v[54:55] op_sel_hi:[0,1]
  v_pk_mul_f32 v[24:25], v[20:21], v[56:57] op_sel_hi:[0,1]
  ds_write_addtid_b32 v42 offset:5152
  ds_write_addtid_b32 v43 offset:8256
  v_pk_fma_f32 v[52:53], v[52:53], v[54:55], v[22:23] op_sel:[1,1,0] op_sel_hi:[1,0,1] neg_lo:[1,0,0]
  v_pk_fma_f32 v[20:21], v[20:21], v[56:57], v[24:25] op_sel:[1,1,0] op_sel_hi:[1,0,1] neg_lo:[1,0,0]
  v_cvt_pk_bf16_f32 v40, v52, v53
  v_cvt_pk_bf16_f32 v41, v20, v21
  v_pk_mul_f32 v[22:23], v[52:53], v[54:55] op_sel_hi:[0,1]
  v_pk_mul_f32 v[24:25], v[20:21], v[56:57] op_sel_hi:[0,1]
  ds_write_addtid_b32 v40 offset:9280
  ds_write_addtid_b32 v41 offset:12384
  v_pk_fma_f32 v[52:53], v[52:53], v[54:55], v[22:23] op_sel:[1,1,0] op_sel_hi:[1,0,1] neg_lo:[1,0,0]
  v_pk_fma_f32 v[20:21], v[20:21], v[56:57], v[24:25] op_sel:[1,1,0] op_sel_hi:[1,0,1] neg_lo:[1,0,0]
  v_cvt_pk_bf16_f32 v42, v52, v53
  v_cvt_pk_bf16_f32 v43, v20, v21
  v_pk_mul_f32 v[22:23], v[52:53], v[54:55] op_sel_hi:[0,1]
  v_pk_mul_f32 v[24:25], v[20:21], v[56:57] op_sel_hi:[0,1]
  ds_write_addtid_b32 v42 offset:13408
  ds_write_addtid_b32 v43 offset:16512
  v_pk_fma_f32 v[52:53], v[52:53], v[54:55], v[22:23] op_sel:[1,1,0] op_sel_hi:[1,0,1] neg_lo:[1,0,0]
  v_pk_fma_f32 v[20:21], v[20:21], v[56:57], v[24:25] op_sel:[1,1,0] op_sel_hi:[1,0,1] neg_lo:[1,0,0]
  v_cvt_pk_bf16_f32 v40, v52, v53
  v_cvt_pk_bf16_f32 v41, v20, v21
  v_pk_mul_f32 v[22:23], v[52:53], v[54:55] op_sel_hi:[0,1]
  v_pk_mul_f32 v[24:25], v[20:21], v[56:57] op_sel_hi:[0,1]
  ds_write_addtid_b32 v40 offset:17536
  ds_write_addtid_b32 v41 offset:20640
  v_pk_fma_f32 v[52:53], v[52:53], v[54:55], v[22:23] op_sel:[1,1,0] op_sel_hi:[1,0,1] neg_lo:[1,0,0]
  v_pk_fma_f32 v[20:21], v[20:21], v[56:57], v[24:25] op_sel:[1,1,0] op_sel_hi:[1,0,1] neg_lo:[1,0,0]
  s_branch L_kgmid
L_kg1a:
  v_mov_b32 v44, 0x3f80
  ds_write_addtid_b32 v44
  v_pk_mul_f32 v[38:39], v[52:53], v[56:57] op_sel_hi:[0,1]
  v_pk_fma_f32 v[20:21], v[52:53], v[56:57], v[38:39] op_sel:[1,1,0] op_sel_hi:[1,0,1] neg_lo:[1,0,0]
  v_pk_mul_f32 v[38:39], v[20:21], v[54:55] op_sel_hi:[0,1]
  v_cvt_pk_bf16_f32 v42, v20, v21
  ds_write_addtid_b32 v42 offset:2048
  v_pk_fma_f32 v[22:23], v[20:21], v[54:55], v[38:39] op_sel:[1,1,0] op_sel_hi:[1,0,1] neg_lo:[1,0,0]
  v_pk_mul_f32 v[38:39], v[22:23], v[54:55] op_sel_hi:[0,1]
  v_cvt_pk_bf16_f32 v43, v22, v23
  ds_write_addtid_b32 v43 offset:6176
  v_pk_fma_f32 v[24:25], v[22:23], v[54:55], v[38:39] op_sel:[1,1,0] op_sel_hi:[1,0,1] neg_lo:[1,0,0]
  v_pk_mul_f32 v[38:39], v[24:25], v[54:55] op_sel_hi:[0,1]
  v_cvt_pk_bf16_f32 v40, v24, v25
  ds_write_addtid_b32 v40 offset:10304
  v_pk_fma_f32 v[26:27], v[24:25], v[54:55], v[38:39] op_sel:[1,1,0] op_sel_hi:[1,0,1] neg_lo:[1,0,0]
  v_pk_mul_f32 v[38:39], v[26:27], v[54:55] op_sel_hi:[0,1]
  v_cvt_pk_bf16_f32 v41, v26, v27
  ds_write_addtid_b32 v41 offset:14432
  v_pk_fma_f32 v[28:29], v[26:27], v[54:55], v[38:39] op_sel:[1,1,0] op_sel_hi:[1,0,1] neg_lo:[1,0,0]
  v_pk_mul_f32 v[38:39], v[28:29], v[54:55] op_sel_hi:[0,1]
  v_cvt_pk_bf16_f32 v42, v28, v29
  ds_write_addtid_b32 v42 offset:18560
  v_pk_fma_f32 v[30:31], v[28:29], v[54:55], v[38:39] op_sel:[1,1,0] op_sel_hi:[1,0,1] neg_lo:[1,0,0]
  v_pk_mul_f32 v[38:39], v[30:31], v[54:55] op_sel_hi:[0,1]
  v_cvt_pk_bf16_f32 v43, v30, v31
  ds_write_addtid_b32 v43 offset:22688
  v_pk_fma_f32 v[32:33], v[30:31], v[54:55], v[38:39] op_sel:[1,1,0] op_sel_hi:[1,0,1] neg_lo:[1,0,0]
  v_pk_mul_f32 v[38:39], v[32:33], v[54:55] op_sel_hi:[0,1]
  v_cvt_pk_bf16_f32 v40, v32, v33
  ds_write_addtid_b32 v40 offset:26816
  v_pk_fma_f32 v[34:35], v[32:33], v[54:55], v[38:39] op_sel:[1,1,0] op_sel_hi:[1,0,1] neg_lo:[1,0,0]
  v_pk_mul_f32 v[38:39], v[34:35], v[54:55] op_sel_hi:[0,1]
  v_cvt_pk_bf16_f32 v41, v34, v35
  ds_write_addtid_b32 v41 offset:30944
  v_pk_fma_f32 v[36:37], v[34:35], v[54:55], v[38:39] op_sel:[1,1,0] op_sel_hi:[1,0,1] neg_lo:[1,0,0]
  v_cvt_pk_bf16_f32 v42, v36, v37
  ds_write_addtid_b32 v42 offset:2560
L_kgmid:
  s_cmp_eq_u32 s59, 1
  s_cbranch_scc1 L_A_nt1
  s_waitcnt vmcnt(0)
  s_cmp_eq_u32 s59, 0
  s_cbranch_scc1 L_A_nt0
  s_setprio 1
  ds_write_b128 v120, v[124:127] offset:35712
  s_waitcnt lgkmcnt(0)
  s_barrier
  ds_read_u16 v96, v121 offset:35712
  ds_read_u16 v97, v121 offset:35840
  ds_read_u16 v98, v121 offset:35968
  ds_read_u16 v99, v121 offset:36096
  ds_read_u16 v100, v121 offset:36224
  ds_read_u16 v101, v121 offset:36352
  ds_read_u16 v102, v121 offset:36480
  ds_read_u16 v103, v121 offset:36608
  s_waitcnt lgkmcnt(6)
  v_lshl_or_b32 v96, v97, 16, v96
  s_waitcnt lgkmcnt(4)
  v_lshl_or_b32 v97, v99, 16, v98
  s_waitcnt lgkmcnt(2)
  v_lshl_or_b32 v98, v101, 16, v100
  s_waitcnt lgkmcnt(0)
  v_lshl_or_b32 v99, v103, 16, v102
  v_bitop3_b32 v96, v96, s97, 1 bitop3:0xea
  v_or_b32 v97, s99, v97
  v_bitop3_b32 v98, v98, -2, s98 bitop3:0xea
  v_and_b32 v99, s97, v99
  global_store_dwordx4 v122, v[96:99], s[60:61] sc1
  s_setprio 1
L_A_nt0:
  global_load_dwordx4 v[104:107], v[86:87], off
  global_load_dwordx4 v[108:111], v[86:87], off offset:1024
  global_load_dwordx4 v[112:115], v[86:87], off offset:2048
  global_load_dwordx4 v[116:119], v[86:87], off offset:3072
L_A_nt1:
  s_cmp_ge_u32 s46, 2
  s_cbranch_scc1 L_kg1b
  v_cvt_pk_bf16_f32 v43, v52, v53
  v_cvt_pk_bf16_f32 v40, v20, v21
  v_pk_mul_f32 v[22:23], v[52:53], v[54:55] op_sel_hi:[0,1]
  v_pk_mul_f32 v[24:25], v[20:21], v[56:57] op_sel_hi:[0,1]
  ds_write_addtid_b32 v43 offset:21664
  ds_write_addtid_b32 v40 offset:24768
  v_pk_fma_f32 v[52:53], v[52:53], v[54:55], v[22:23] op_sel:[1,1,0] op_sel_hi:[1,0,1] neg_lo:[1,0,0]
  v_pk_fma_f32 v[20:21], v[20:21], v[56:57], v[24:25] op_sel:[1,1,0] op_sel_hi:[1,0,1] neg_lo:[1,0,0]
  v_cvt_pk_bf16_f32 v41, v52, v53
  v_cvt_pk_bf16_f32 v42, v20, v21
  v_pk_mul_f32 v[22:23], v[52:53], v[54:55] op_sel_hi:[0,1]
  v_pk_mul_f32 v[24:25], v[20:21], v[56:57] op_sel_hi:[0,1]
  ds_write_addtid_b32 v41 offset:25792
  ds_write_addtid_b32 v42 offset:28896
  v_pk_fma_f32 v[52:53], v[52:53], v[54:55], v[22:23] op_sel:[1,1,0] op_sel_hi:[1,0,1] neg_lo:[1,0,0]
  v_pk_fma_f32 v[20:21], v[20:21], v[56:57], v[24:25] op_sel:[1,1,0] op_sel_hi:[1,0,1] neg_lo:[1,0,0]
  v_cvt_pk_bf16_f32 v43, v52, v53
  v_cvt_pk_bf16_f32 v40, v20, v21
  v_pk_mul_f32 v[22:23], v[52:53], v[54:55] op_sel_hi:[0,1]
  v_pk_mul_f32 v[24:25], v[20:21], v[56:57] op_sel_hi:[0,1]
  ds_write_addtid_b32 v43 offset:29920
  ds_write_addtid_b32 v40 offset:512
  v_pk_fma_f32 v[52:53], v[52:53], v[54:55], v[22:23] op_sel:[1,1,0] op_sel_hi:[1,0,1] neg_lo:[1,0,0]
  v_pk_fma_f32 v[20:21], v[20:21], v[56:57], v[24:25] op_sel:[1,1,0] op_sel_hi:[1,0,1] neg_lo:[1,0,0]
  v_cvt_pk_bf16_f32 v41, v52, v53
  v_cvt_pk_bf16_f32 v42, v20, v21
  v_pk_mul_f32 v[22:23], v[52:53], v[54:55] op_sel_hi:[0,1]
  v_pk_mul_f32 v[24:25], v[20:21], v[56:57] op_sel_hi:[0,1]
  ds_write_addtid_b32 v41 offset:1536
  ds_write_addtid_b32 v42 offset:4640
  v_pk_fma_f32 v[52:53], v[52:53], v[54:55], v[22:23] op_sel:[1,1,0] op_sel_hi:[1,0,1] neg_lo:[1,0,0]
  v_pk_fma_f32 v[20:21], v[20:21], v[56:57], v[24:25] op_sel:[1,1,0] op_sel_hi:[1,0,1] neg_lo:[1,0,0]
  v_cvt_pk_bf16_f32 v43, v52, v53
  v_cvt_pk_bf16_f32 v40, v20, v21
  v_pk_mul_f32 v[22:23], v[52:53], v[54:55] op_sel_hi:[0,1]
  v_pk_mul_f32 v[24:25], v[20:21], v[56:57] op_sel_hi:[0,1]
  ds_write_addtid_b32 v43 offset:5664
  ds_write_addtid_b32 v40 offset:8768
  v_pk_fma_f32 v[52:53], v[52:53], v[54:55], v[22:23] op_sel:[1,1,0] op_sel_hi:[1,0,1] neg_lo:[1,0,0]
  v_pk_fma_f32 v[20:21], v[20:21], v[56:57], v[24:25] op_sel:[1,1,0] op_sel_hi:[1,0,1] neg_lo:[1,0,0]
  v_cvt_pk_bf16_f32 v41, v52, v53
  v_cvt_pk_bf16_f32 v42, v20, v21
  v_pk_mul_f32 v[22:23], v[52:53], v[54:55] op_sel_hi:[0,1]
  v_pk_mul_f32 v[24:25], v[20:21], v[56:57] op_sel_hi:[0,1]
  ds_write_addtid_b32 v41 offset:9792
  ds_write_addtid_b32 v42 offset:12896
  v_pk_fma_f32 v[52:53], v[52:53], v[54:55], v[22:23] op_sel:[1,1,0] op_sel_hi:[1,0,1] neg_lo:[1,0,0]
  v_pk_fma_f32 v[20:21], v[20:21], v[56:57], v[24:25] op_sel:[1,1,0] op_sel_hi:[1,0,1] neg_lo:[1,0,0]
  v_cvt_pk_bf16_f32 v43, v52, v53
  v_cvt_pk_bf16_f32 v40, v20, v21
  v_pk_mul_f32 v[22:23], v[52:53], v[54:55] op_sel_hi:[0,1]
  v_pk_mul_f32 v[24:25], v[20:21], v[56:57] op_sel_hi:[0,1]
  ds_write_addtid_b32 v43 offset:13920
  ds_write_addtid_b32 v40 offset:17024
  v_pk_fma_f32 v[52:53], v[52:53], v[54:55], v[22:23] op_sel:[1,1,0] op_sel_hi:[1,0,1] neg_lo:[1,0,0]
  v_pk_fma_f32 v[20:21], v[20:21], v[56:57], v[24:25] op_sel:[1,1,0] op_sel_hi:[1,0,1] neg_lo:[1,0,0]
  v_cvt_pk_bf16_f32 v41, v52, v53
  v_cvt_pk_bf16_f32 v42, v20, v21
  v_pk_mul_f32 v[22:23], v[52:53], v[54:55] op_sel_hi:[0,1]
  v_pk_mul_f32 v[24:25], v[20:21], v[56:57] op_sel_hi:[0,1]
  ds_write_addtid_b32 v41 offset:18048
  ds_write_addtid_b32 v42 offset:21152
  v_pk_fma_f32 v[52:53], v[52:53], v[54:55], v[22:23] op_sel:[1,1,0] op_sel_hi:[1,0,1] neg_lo:[1,0,0]
  v_pk_fma_f32 v[20:21], v[20:21], v[56:57], v[24:25] op_sel:[1,1,0] op_sel_hi:[1,0,1] neg_lo:[1,0,0]
  v_cvt_pk_bf16_f32 v43, v52, v53
  v_cvt_pk_bf16_f32 v40, v20, v21
  v_pk_mul_f32 v[22:23], v[52:53], v[54:55] op_sel_hi:[0,1]
  v_pk_mul_f32 v[24:25], v[20:21], v[56:57] op_sel_hi:[0,1]
  ds_write_addtid_b32 v43 offset:22176
  ds_write_addtid_b32 v40 offset:25280
  v_pk_fma_f32 v[52:53], v[52:53], v[54:55], v[22:23] op_sel:[1,1,0] op_sel_hi:[1,0,1] neg_lo:[1,0,0]
  v_pk_fma_f32 v[20:21], v[20:21], v[56:57], v[24:25] op_sel:[1,1,0] op_sel_hi:[1,0,1] neg_lo:[1,0,0]
  v_cvt_pk_bf16_f32 v41, v52, v53
  v_cvt_pk_bf16_f32 v42, v20, v21
  v_pk_mul_f32 v[22:23], v[52:53], v[54:55] op_sel_hi:[0,1]
  ds_write_addtid_b32 v42 offset:29408
  ds_write_addtid_b32 v41 offset:26304
  v_pk_fma_f32 v[52:53], v[52:53], v[54:55], v[22:23] op_sel:[1,1,0] op_sel_hi:[1,0,1] neg_lo:[1,0,0]
  v_cvt_pk_bf16_f32 v43, v52, v53
  ds_write_addtid_b32 v43 offset:30432
  s_branch L_kgdone
L_kg1b:
  v_pk_mul_f32 v[64:65], v[20:21], v[56:57] op_sel_hi:[0,1]
  v_pk_mul_f32 v[66:67], v[24:25], v[56:57] op_sel_hi:[0,1]
  v_pk_mul_f32 v[68:69], v[28:29], v[56:57] op_sel_hi:[0,1]
  v_pk_mul_f32 v[70:71], v[32:33], v[56:57] op_sel_hi:[0,1]
  v_pk_mul_f32 v[72:73], v[36:37], v[56:57] op_sel_hi:[0,1]
  v_pk_fma_f32 v[20:21], v[20:21], v[56:57], v[64:65] op_sel:[1,1,0] op_sel_hi:[1,0,1] neg_lo:[1,0,0]
  v_pk_fma_f32 v[24:25], v[24:25], v[56:57], v[66:67] op_sel:[1,1,0] op_sel_hi:[1,0,1] neg_lo:[1,0,0]
  v_pk_fma_f32 v[28:29], v[28:29], v[56:57], v[68:69] op_sel:[1,1,0] op_sel_hi:[1,0,1] neg_lo:[1,0,0]
  v_pk_fma_f32 v[32:33], v[32:33], v[56:57], v[70:71] op_sel:[1,1,0] op_sel_hi:[1,0,1] neg_lo:[1,0,0]
  v_pk_fma_f32 v[36:37], v[36:37], v[56:57], v[72:73] op_sel:[1,1,0] op_sel_hi:[1,0,1] neg_lo:[1,0,0]
  v_cvt_pk_bf16_f32 v40, v20, v21
  v_cvt_pk_bf16_f32 v41, v24, v25
  v_cvt_pk_bf16_f32 v42, v28, v29
  ds_write_addtid_b32 v40 offset:6688
  ds_write_addtid_b32 v41 offset:10816
  ds_write_addtid_b32 v42 offset:14944
  v_cvt_pk_bf16_f32 v43, v32, v33
  v_cvt_pk_bf16_f32 v40, v36, v37
  ds_write_addtid_b32 v43 offset:19072
  ds_write_addtid_b32 v40 offset:23200
  v_pk_mul_f32 v[64:65], v[20:21], v[56:57] op_sel_hi:[0,1]
  v_pk_mul_f32 v[66:67], v[24:25], v[56:57] op_sel_hi:[0,1]
  v_pk_mul_f32 v[68:69], v[28:29], v[56:57] op_sel_hi:[0,1]
  v_pk_mul_f32 v[70:71], v[32:33], v[56:57] op_sel_hi:[0,1]
  v_pk_mul_f32 v[72:73], v[36:37], v[56:57] op_sel_hi:[0,1]
  v_pk_fma_f32 v[20:21], v[20:21], v[56:57], v[64:65] op_sel:[1,1,0] op_sel_hi:[1,0,1] neg_lo:[1,0,0]
  v_pk_fma_f32 v[24:25], v[24:25], v[56:57], v[66:67] op_sel:[1,1,0] op_sel_hi:[1,0,1] neg_lo:[1,0,0]
  v_pk_fma_f32 v[28:29], v[28:29], v[56:57], v[68:69] op_sel:[1,1,0] op_sel_hi:[1,0,1] neg_lo:[1,0,0]
  v_pk_fma_f32 v[32:33], v[32:33], v[56:57], v[70:71] op_sel:[1,1,0] op_sel_hi:[1,0,1] neg_lo:[1,0,0]
  v_pk_fma_f32 v[36:37], v[36:37], v[56:57], v[72:73] op_sel:[1,1,0] op_sel_hi:[1,0,1] neg_lo:[1,0,0]
  v_cvt_pk_bf16_f32 v41, v20, v21
  v_cvt_pk_bf16_f32 v42, v24, v25
  v_cvt_pk_bf16_f32 v43, v28, v29
  ds_write_addtid_b32 v41 offset:27328
  ds_write_addtid_b32 v42 offset:31456
  ds_write_addtid_b32 v43 offset:3072
  v_cvt_pk_bf16_f32 v40, v32, v33
  v_cvt_pk_bf16_f32 v41, v36, v37
  ds_write_addtid_b32 v40 offset:7200
  ds_write_addtid_b32 v41 offset:11328
  v_pk_mul_f32 v[64:65], v[28:29], v[56:57] op_sel_hi:[0,1]
  v_pk_mul_f32 v[66:67], v[36:37], v[56:57] op_sel_hi:[0,1]
  v_pk_fma_f32 v[28:29], v[28:29], v[56:57], v[64:65] op_sel:[1,1,0] op_sel_hi:[1,0,1] neg_lo:[1,0,0]
  v_pk_fma_f32 v[36:37], v[36:37], v[56:57], v[66:67] op_sel:[1,1,0] op_sel_hi:[1,0,1] neg_lo:[1,0,0]
  v_cvt_pk_bf16_f32 v42, v28, v29
  v_cvt_pk_bf16_f32 v43, v36, v37
  ds_write_addtid_b32 v42 offset:15456
  ds_write_addtid_b32 v43 offset:19584
  v_pk_mul_f32 v[64:65], v[28:29], v[56:57] op_sel_hi:[0,1]
  v_pk_mul_f32 v[66:67], v[36:37], v[56:57] op_sel_hi:[0,1]
  v_pk_fma_f32 v[28:29], v[28:29], v[56:57], v[64:65] op_sel:[1,1,0] op_sel_hi:[1,0,1] neg_lo:[1,0,0]
  v_pk_fma_f32 v[36:37], v[36:37], v[56:57], v[66:67] op_sel:[1,1,0] op_sel_hi:[1,0,1] neg_lo:[1,0,0]
  v_cvt_pk_bf16_f32 v40, v28, v29
  v_cvt_pk_bf16_f32 v41, v36, v37
  ds_write_addtid_b32 v40 offset:23712
  ds_write_addtid_b32 v41 offset:27840
  v_pk_mul_f32 v[64:65], v[28:29], v[56:57] op_sel_hi:[0,1]
  v_pk_mul_f32 v[66:67], v[36:37], v[56:57] op_sel_hi:[0,1]
  v_pk_fma_f32 v[28:29], v[28:29], v[56:57], v[64:65] op_sel:[1,1,0] op_sel_hi:[1,0,1] neg_lo:[1,0,0]
  v_pk_fma_f32 v[36:37], v[36:37], v[56:57], v[66:67] op_sel:[1,1,0] op_sel_hi:[1,0,1] neg_lo:[1,0,0]
  v_cvt_pk_bf16_f32 v42, v28, v29
  v_cvt_pk_bf16_f32 v43, v36, v37
  ds_write_addtid_b32 v42 offset:31968
  ds_write_addtid_b32 v43 offset:3584
  v_pk_mul_f32 v[64:65], v[28:29], v[56:57] op_sel_hi:[0,1]
  v_pk_mul_f32 v[66:67], v[36:37], v[56:57] op_sel_hi:[0,1]
  v_pk_fma_f32 v[28:29], v[28:29], v[56:57], v[64:65] op_sel:[1,1,0] op_sel_hi:[1,0,1] neg_lo:[1,0,0]
  v_pk_fma_f32 v[36:37], v[36:37], v[56:57], v[66:67] op_sel:[1,1,0] op_sel_hi:[1,0,1] neg_lo:[1,0,0]
  v_cvt_pk_bf16_f32 v40, v28, v29
  v_cvt_pk_bf16_f32 v41, v36, v37
  ds_write_addtid_b32 v40 offset:7712
  ds_write_addtid_b32 v41 offset:11840
L_kgdone:
  s_setprio 3
  v_add_u32_sdwa v4, s48, v88 dst_sel:DWORD dst_unused:UNUSED_PAD src0_sel:DWORD src1_sel:WORD_0
  v_add_u32_sdwa v5, s48, v88 dst_sel:DWORD dst_unused:UNUSED_PAD src0_sel:DWORD src1_sel:WORD_1
  s_waitcnt lgkmcnt(0)
  s_barrier
  ds_read_b128 v[16:19], v4 offset:0
  ds_read_b128 v[20:23], v5 offset:0
  ds_read_b128 v[24:27], v4 offset:64
  ds_read_b128 v[28:31], v5 offset:64
  ds_read_b128 v[32:35], v4 offset:128
  ds_read_b128 v[36:39], v5 offset:128
  ds_read_b128 v[40:43], v4 offset:192
  ds_read_b128 v[44:47], v5 offset:192
  ds_read_b128 v[48:51], v4 offset:256
  ds_read_b128 v[52:55], v5 offset:256
  ds_read_b128 v[56:59], v4 offset:320
  ds_read_b128 v[60:63], v5 offset:320
  ds_read_b128 v[64:67], v4 offset:384
  ds_read_b128 v[68:71], v5 offset:384
  ds_read_b128 v[72:75], v4 offset:448
  ds_read_b128 v[76:79], v5 offset:448
  v_add_u32_sdwa v6, s48, v89 dst_sel:DWORD dst_unused:UNUSED_PAD src0_sel:DWORD src1_sel:WORD_0
  v_add_u32_sdwa v7, s48, v89 dst_sel:DWORD dst_unused:UNUSED_PAD src0_sel:DWORD src1_sel:WORD_1
  v_add_u32_sdwa v13, s48, v90 dst_sel:DWORD dst_unused:UNUSED_PAD src0_sel:DWORD src1_sel:WORD_0
  v_add_u32_sdwa v14, s48, v90 dst_sel:DWORD dst_unused:UNUSED_PAD src0_sel:DWORD src1_sel:WORD_1
  v_add_u32_sdwa v15, s48, v91 dst_sel:DWORD dst_unused:UNUSED_PAD src0_sel:DWORD src1_sel:WORD_0
  v_add_u32_sdwa v8, s48, v91 dst_sel:DWORD dst_unused:UNUSED_PAD src0_sel:DWORD src1_sel:WORD_1
  s_mul_i32 s36, s46, 384
  v_subrev_u32 v4, s36, v7
  s_waitcnt lgkmcnt(14)
  v_mfma_f32_16x16x32_bf16 v[80:83], v[16:19], v[20:23], 0
  s_waitcnt lgkmcnt(12)
  v_mfma_f32_16x16x32_bf16 v[80:83], v[24:27], v[28:31], v[80:83]
  s_waitcnt lgkmcnt(10)
  v_mfma_f32_16x16x32_bf16 v[80:83], v[32:35], v[36:39], v[80:83]
  s_waitcnt lgkmcnt(8)
  v_mfma_f32_16x16x32_bf16 v[80:83], v[40:43], v[44:47], v[80:83]
  s_waitcnt lgkmcnt(6)
  v_mfma_f32_16x16x32_bf16 v[80:83], v[48:51], v[52:55], v[80:83]
  s_waitcnt lgkmcnt(4)
  v_mfma_f32_16x16x32_bf16 v[80:83], v[56:59], v[60:63], v[80:83]
  s_waitcnt lgkmcnt(2)
  v_mfma_f32_16x16x32_bf16 v[80:83], v[64:67], v[68:71], v[80:83]
  s_waitcnt lgkmcnt(0)
  v_mfma_f32_16x16x32_bf16 v[80:83], v[72:75], v[76:79], v[80:83]
  s_cmp_eq_u32 s46, 2
  s_cbranch_scc1 L_ke2
  s_cmp_eq_u32 s46, 3
  s_cbranch_scc1 L_ke3
  s_nop 3
  v_cvt_pk_bf16_f32 v84, v80, v81
  v_cvt_pk_bf16_f32 v85, v82, v83
  ds_write_b64 v13, v[84:85]
  s_branch L_kedone
L_ke2:
  v_subrev_u32 v5, 16, v13
  v_mov_b32 v88, 0
  s_nop 3
  v_cvt_pk_bf16_f32 v84, v80, v80
  v_cvt_pk_bf16_f32 v85, v81, v81
  v_cvt_pk_bf16_f32 v86, v81, v82
  v_cvt_pk_bf16_f32 v87, v82, v82
  ds_write_b128 v13, v[84:87]
  v_and_b32 v89, 0xffff0000, v84
  v_mov_b32 v90, v84
  v_mov_b32 v91, v84
  s_mov_b64 exec, 0x8000
  ds_write_b128 v5, v[88:91]
  s_mov_b64 exec, -1
  s_branch L_kedone
L_ke3:
  s_nop 3
  v_cvt_pk_bf16_f32 v84, v81, v80
  ds_write_b16 v13, v84
  ds_write_b16_d16_hi v13, v84 offset:160
L_kedone:
  s_waitcnt vmcnt(0)
  global_load_dwordx4 v[92:95], v2, s[40:41] sc1
  s_waitcnt lgkmcnt(0)
  s_barrier
  s_cmp_eq_u32 s46, 0
  s_cbranch_scc1 L_nocopy
  s_mov_b64 exec, s[42:43]
  ds_read_b128 v[20:23], v11 offset:30976
  ds_read_b64 v[24:25], v11 offset:30992
  s_waitcnt lgkmcnt(1)
  v_alignbit_b32 v28, v21, v20, 16
  v_alignbit_b32 v29, v22, v21, 16
  v_alignbit_b32 v30, v23, v22, 16
  v_mov_b32 v32, v21
  v_mov_b32 v33, v22
  v_mov_b32 v34, v23
  s_waitcnt lgkmcnt(0)
  v_cndmask_b32 v35, v24, 0, s[44:45]
  v_cndmask_b32 v25, v25, 0, s[44:45]
  ds_write_b128 v11, v[32:35] offset:2688
  v_alignbit_b32 v31, v35, v23, 16
  v_mov_b32 v36, v29
  v_mov_b32 v37, v30
  ds_write_b128 v11, v[28:31] offset:64
  v_mov_b32 v38, v31
  v_alignbit_b32 v39, v25, v35, 16
  ds_write_b128 v11, v[36:39] offset:5312
L_nocopy:
  s_mov_b32 exec_lo, -1
  s_mov_b32 exec_hi, 0x3f
  ds_write_b32 v14, v3
  s_mov_b64 exec, -1
L_pu_chk:
  s_waitcnt vmcnt(0)
  v_bitop3_b32 v16, v92, v94, 1 bitop3:0xdb
  v_bitop3_b32 v16, v16, v93, v95 bitop3:0xfb
  v_and_b32 v16, s99, v16
  v_cmp_ne_u32 vcc, 0, v16
  s_nop 0
  s_cbranch_vccz L_pu_ok
  s_cmp_eq_u32 s96, 0
  s_cbranch_scc1 L_pu_ok
  s_sub_u32 s96, s96, 1
  s_wqm_b64 exec, vcc
  s_sleep 1
  global_load_dwordx4 v[92:95], v2, s[40:41] sc1
  s_branch L_pu_chk
L_pu_ok:
  s_mov_b64 exec, -1
  ds_write_b128 v11, v[92:95] offset:35680
  s_waitcnt lgkmcnt(0)
  s_barrier
  s_setprio 0
  ds_read_b128 v[68:71], v4 offset:1600
  ds_read_b128 v[72:75], v4 offset:1584
  ds_read_b64 v[60:61], v6 offset:2112
  ds_read_b64 v[62:63], v6 offset:2120
  ds_read_b128 v[80:83], v7 offset:64
  ds_read_b128 v[84:87], v7 offset:576
  ds_read_b128 v[88:91], v7 offset:1088
  ds_read_b128 v[92:95], v7 offset:1600
  ds_read_b128 v[96:99], v7 offset:2112
  ds_read_b64 v[56:57], v6 offset:2624
  ds_read_b64 v[58:59], v6 offset:2632
  ds_read_b128 v[100:103], v7 offset:2624
  ds_read_b64 v[64:65], v6 offset:1600
  ds_read_b64 v[66:67], v6 offset:1608
  s_waitcnt lgkmcnt(13)
  v_mfma_f32_16x16x32_bf16 v[76:79], v[68:71], v[104:107], 0
  s_waitcnt lgkmcnt(12)
  v_mfma_f32_16x16x32_bf16 v[68:71], v[72:75], v[108:111], 0
  ds_read_b64 v[52:53], v6 offset:3136
  ds_read_b64 v[54:55], v6 offset:3144
  ds_read_b128 v[104:107], v7 offset:3136
  ds_read_b64 v[48:49], v6 offset:3648
  ds_read_b64 v[50:51], v6 offset:3656
  ds_read_b128 v[108:111], v7 offset:3648
  s_waitcnt lgkmcnt(14)
  v_mfma_f32_16x16x32_bf16 v[28:31], v[60:63], v[80:83], 0
  v_mfma_f32_16x16x32_bf16 v[32:35], v[60:63], v[84:87], 0
  s_waitcnt lgkmcnt(13)
  v_mfma_f32_16x16x32_bf16 v[36:39], v[60:63], v[88:91], 0
  s_waitcnt lgkmcnt(12)
  v_mfma_f32_16x16x32_bf16 v[40:43], v[60:63], v[92:95], 0
  s_waitcnt lgkmcnt(11)
  v_mfma_f32_16x16x32_bf16 v[44:47], v[60:63], v[96:99], 0
  ds_read_b64 v[60:61], v8 offset:1760
  ds_read_b64 v[62:63], v8 offset:1920
  s_waitcnt lgkmcnt(11)
  v_mfma_f32_16x16x32_bf16 v[24:27], v[56:59], v[80:83], 0
  v_cvt_pk_bf16_f32 v72, v76, v77
  v_mfma_f32_16x16x32_bf16 v[28:31], v[56:59], v[84:87], v[28:31]
  v_cvt_pk_bf16_f32 v73, v78, v79
  v_mfma_f32_16x16x32_bf16 v[32:35], v[56:59], v[88:91], v[32:35]
  v_cvt_pk_bf16_f32 v74, v68, v69
  v_mfma_f32_16x16x32_bf16 v[36:39], v[56:59], v[92:95], v[36:39]
  v_cvt_pk_bf16_f32 v75, v70, v71
  v_mfma_f32_16x16x32_bf16 v[40:43], v[56:59], v[96:99], v[40:43]
  s_waitcnt lgkmcnt(10)
  v_mfma_f32_16x16x32_bf16 v[44:47], v[56:59], v[100:103], v[44:47]
  ds_read_b64 v[56:57], v6 offset:2560
  ds_read_b64 v[58:59], v6 offset:2568
  s_cmp_lg_u32 s46, 0
  s_cbranch_scc1 L_c32
  s_waitcnt lgkmcnt(10)
  v_mfma_f32_16x16x32_bf16 v[32:35], v[64:67], v[80:83], v[32:35]
  v_mfma_f32_16x16x32_bf16 v[36:39], v[64:67], v[84:87], v[36:39]
  v_mfma_f32_16x16x32_bf16 v[40:43], v[64:67], v[88:91], v[40:43]
  v_mfma_f32_16x16x32_bf16 v[44:47], v[64:67], v[92:95], v[44:47]
L_c32:
  s_waitcnt lgkmcnt(11)
  ds_read_b64 v[64:65], v8 offset:1664
  s_waitcnt lgkmcnt(11)
  ds_read_b64 v[66:67], v8 offset:1824
  ds_read_b64 v[68:69], v8 offset:1696
  ds_read_b64 v[70:71], v8 offset:1856
  ds_read_b64 v[76:77], v8 offset:1728
  ds_read_b64 v[78:79], v8 offset:1888
  s_waitcnt lgkmcnt(14)
  v_mfma_f32_16x16x32_bf16 v[20:23], v[52:55], v[80:83], 0
  v_mfma_f32_16x16x32_bf16 v[24:27], v[52:55], v[84:87], v[24:27]
  v_mfma_f32_16x16x32_bf16 v[28:31], v[52:55], v[88:91], v[28:31]
  v_mfma_f32_16x16x32_bf16 v[32:35], v[52:55], v[92:95], v[32:35]
  v_mfma_f32_16x16x32_bf16 v[36:39], v[52:55], v[96:99], v[36:39]
  v_mfma_f32_16x16x32_bf16 v[40:43], v[52:55], v[100:103], v[40:43]
  s_waitcnt lgkmcnt(13)
  v_mfma_f32_16x16x32_bf16 v[44:47], v[52:55], v[104:107], v[44:47]
  ds_read_b64 v[52:53], v6 offset:3072
  ds_read_b64 v[54:55], v6 offset:3080
  s_waitcnt lgkmcnt(6)
  v_mfma_f32_16x16x32_bf16 v[44:47], v[72:75], v[64:67], v[44:47]
  s_cmp_lt_u32 s46, 1
  s_cbranch_scc1 L_far
  s_waitcnt lgkmcnt(4)
  v_mfma_f32_16x16x32_bf16 v[40:43], v[72:75], v[68:71], v[40:43]
  s_cmp_lt_u32 s46, 2
  s_cbranch_scc1 L_far
  s_waitcnt lgkmcnt(2)
  v_mfma_f32_16x16x32_bf16 v[36:39], v[72:75], v[76:79], v[36:39]
  s_cmp_lt_u32 s46, 3
  s_cbranch_scc1 L_far
  v_mfma_f32_16x16x32_bf16 v[32:35], v[72:75], v[60:63], v[32:35]
L_far:
  ds_read_b64 v[60:61], v6 offset:2048
  ds_read_b64 v[62:63], v6 offset:2056
  v_mfma_f32_16x16x32_bf16 v[16:19], v[48:51], v[80:83], 0
  ds_read_b128 v[80:83], v7 offset:0
  v_mfma_f32_16x16x32_bf16 v[20:23], v[48:51], v[84:87], v[20:23]
  ds_read_b128 v[84:87], v7 offset:512
  v_mfma_f32_16x16x32_bf16 v[24:27], v[48:51], v[88:91], v[24:27]
  ds_read_b128 v[88:91], v7 offset:1024
  v_mfma_f32_16x16x32_bf16 v[28:31], v[48:51], v[92:95], v[28:31]
  ds_read_b128 v[92:95], v7 offset:1536
  v_mfma_f32_16x16x32_bf16 v[32:35], v[48:51], v[96:99], v[32:35]
  ds_read_b128 v[96:99], v7 offset:2048
  v_mfma_f32_16x16x32_bf16 v[36:39], v[48:51], v[100:103], v[36:39]
  ds_read_b128 v[100:103], v7 offset:2560
  v_mfma_f32_16x16x32_bf16 v[40:43], v[48:51], v[104:107], v[40:43]
  ds_read_b128 v[104:107], v7 offset:3072
  v_mfma_f32_16x16x32_bf16 v[44:47], v[48:51], v[108:111], v[44:47]
  ds_read_b128 v[108:111], v7 offset:3584
  ds_read_b64 v[48:49], v6 offset:3584
  ds_read_b64 v[50:51], v6 offset:3592
  s_waitcnt lgkmcnt(9)
  v_mfma_f32_16x16x32_bf16 v[24:27], v[56:59], v[80:83], v[24:27]
  v_mfma_f32_16x16x32_bf16 v[20:23], v[52:55], v[80:83], v[20:23]
  v_mfma_f32_16x16x32_bf16 v[28:31], v[60:63], v[80:83], v[28:31]
  s_waitcnt lgkmcnt(8)
  v_mfma_f32_16x16x32_bf16 v[28:31], v[56:59], v[84:87], v[28:31]
  v_mfma_f32_16x16x32_bf16 v[24:27], v[52:55], v[84:87], v[24:27]
  s_waitcnt lgkmcnt(0)
  v_mfma_f32_16x16x32_bf16 v[16:19], v[48:51], v[80:83], v[16:19]
  v_mfma_f32_16x16x32_bf16 v[20:23], v[48:51], v[84:87], v[20:23]
  v_mfma_f32_16x16x32_bf16 v[28:31], v[52:55], v[88:91], v[28:31]
  v_mfma_f32_16x16x32_bf16 v[24:27], v[48:51], v[88:91], v[24:27]
  v_mfma_f32_16x16x32_bf16 v[28:31], v[48:51], v[92:95], v[28:31]
  v_mfma_f32_16x16x32_bf16 v[32:35], v[60:63], v[84:87], v[32:35]
  v_mfma_f32_16x16x32_bf16 v[32:35], v[56:59], v[88:91], v[32:35]
  v_mfma_f32_16x16x32_bf16 v[32:35], v[52:55], v[92:95], v[32:35]
  v_mfma_f32_16x16x32_bf16 v[32:35], v[48:51], v[96:99], v[32:35]
  v_cvt_pk_bf16_f32 v64, v16, v17
  v_cvt_pk_bf16_f32 v65, v18, v19
  v_mfma_f32_16x16x32_bf16 v[36:39], v[60:63], v[88:91], v[36:39]
  v_cvt_pk_bf16_f32 v66, v20, v21
  v_cvt_pk_bf16_f32 v67, v22, v23
  v_mfma_f32_16x16x32_bf16 v[36:39], v[56:59], v[92:95], v[36:39]
  ds_write_b128 v9, v[64:67] offset:10240
  v_mfma_f32_16x16x32_bf16 v[36:39], v[52:55], v[96:99], v[36:39]
  v_cvt_pk_bf16_f32 v68, v24, v25
  v_cvt_pk_bf16_f32 v69, v26, v27
  v_mfma_f32_16x16x32_bf16 v[36:39], v[48:51], v[100:103], v[36:39]
  v_cvt_pk_bf16_f32 v70, v28, v29
  v_cvt_pk_bf16_f32 v71, v30, v31
  v_mfma_f32_16x16x32_bf16 v[40:43], v[60:63], v[92:95], v[40:43]
  ds_write_b128 v9, v[68:71] offset:11264
  v_mfma_f32_16x16x32_bf16 v[40:43], v[56:59], v[96:99], v[40:43]
  v_mfma_f32_16x16x32_bf16 v[40:43], v[52:55], v[100:103], v[40:43]
  v_mfma_f32_16x16x32_bf16 v[40:43], v[48:51], v[104:107], v[40:43]
  v_mfma_f32_16x16x32_bf16 v[44:47], v[60:63], v[96:99], v[44:47]
  v_cvt_pk_bf16_f32 v72, v32, v33
  v_cvt_pk_bf16_f32 v73, v34, v35
  v_mfma_f32_16x16x32_bf16 v[44:47], v[56:59], v[100:103], v[44:47]
  v_cvt_pk_bf16_f32 v74, v36, v37
  v_cvt_pk_bf16_f32 v75, v38, v39
  v_mfma_f32_16x16x32_bf16 v[44:47], v[52:55], v[104:107], v[44:47]
  ds_write_b128 v9, v[72:75] offset:12288
  v_mfma_f32_16x16x32_bf16 v[44:47], v[48:51], v[108:111], v[44:47]
  s_setprio 2
  v_cvt_pk_bf16_f32 v76, v40, v41
  v_cvt_pk_bf16_f32 v77, v42, v43
  s_nop 4
  v_cvt_pk_bf16_f32 v78, v44, v45
  v_cvt_pk_bf16_f32 v79, v46, v47
  ds_write_b128 v9, v[76:79] offset:13312
  s_waitcnt lgkmcnt(0)
  s_barrier
  ds_read_b128 v[80:83], v15 offset:0
  ds_read_b128 v[84:87], v15 offset:128
  ds_read_b128 v[88:91], v15 offset:256
  ds_read_b128 v[92:95], v15 offset:384
  s_waitcnt lgkmcnt(3)
  v_mfma_f32_16x16x32_bf16 v[16:19], v[112:115], v[80:83], 0
  s_waitcnt lgkmcnt(2)
  v_mfma_f32_16x16x32_bf16 v[16:19], v[116:119], v[84:87], v[16:19]
  s_waitcnt lgkmcnt(1)
  v_mfma_f32_16x16x32_bf16 v[20:23], v[112:115], v[88:91], 0
  s_waitcnt lgkmcnt(0)
  v_mfma_f32_16x16x32_bf16 v[20:23], v[116:119], v[92:95], v[20:23]
  s_nop 3
  v_cvt_pk_bf16_f32 v48, v16, v17
  v_cvt_pk_bf16_f32 v49, v18, v19
  s_nop 1
  v_cvt_pk_bf16_f32 v50, v20, v21
  v_cvt_pk_bf16_f32 v51, v22, v23
  v_bitop3_b32 v50, v50, s97, 1 bitop3:0xea
  v_or_b32 v51, s99, v51
  v_bitop3_b32 v48, v48, -2, s98 bitop3:0xea
  v_and_b32 v49, s97, v49
  s_cmp_lg_u32 s59, 0
  s_cbranch_scc1 L_y2
  global_store_dwordx4 v12, v[48:51], s[40:41] sc1
  s_endpgm
L_y2:
  global_store_dwordx4 v12, v[48:51], s[40:41] sc1
L_tile_out:
  v_and_b32 v16, 0x70, v2
  global_load_dwordx4 v[16:19], v16, s[20:21]
  v_lshlrev_b32 v20, 16, v124
  v_and_b32 v21, 0xffff0000, v124
  v_lshlrev_b32 v22, 16, v125
  v_and_b32 v23, 0xffff0000, v125
  v_lshlrev_b32 v24, 16, v126
  v_and_b32 v25, 0xffff0000, v126
  v_lshlrev_b32 v26, 16, v127
  v_and_b32 v27, 0xffff0000, v127
  s_waitcnt vmcnt(0)
  global_load_dwordx4 v[124:127], v122, s[60:61] sc1
  v_lshlrev_b32 v40, 16, v16
  v_and_b32 v41, 0xffff0000, v16
  v_lshlrev_b32 v42, 16, v17
  v_and_b32 v43, 0xffff0000, v17
  v_lshlrev_b32 v44, 16, v18
  v_and_b32 v45, 0xffff0000, v18
  v_lshlrev_b32 v46, 16, v19
  v_and_b32 v47, 0xffff0000, v19
L_py_chk:
  s_waitcnt vmcnt(0)
  v_bitop3_b32 v28, v126, v124, 1 bitop3:0xdb
  v_bitop3_b32 v28, v28, v127, v125 bitop3:0xfb
  v_and_b32 v28, s99, v28
  v_cmp_ne_u32 vcc, 0, v28
  s_nop 0
  s_cbranch_vccz L_py_ok
  s_cmp_eq_u32 s96, 0
  s_cbranch_scc1 L_py_ok
  s_sub_u32 s96, s96, 1
  s_wqm_b64 exec, vcc
  s_sleep 1
  global_load_dwordx4 v[124:127], v122, s[60:61] sc1
  s_branch L_py_chk
L_py_ok:
  s_mov_b64 exec, -1
  ds_write_b128 v120, v[124:127]
  s_waitcnt lgkmcnt(0)
  s_barrier
  ds_read_u16_d16_hi v32, v121 offset:0
  ds_read_u16_d16_hi v33, v121 offset:128
  ds_read_u16_d16_hi v34, v121 offset:256
  ds_read_u16_d16_hi v35, v121 offset:384
  ds_read_u16_d16_hi v36, v121 offset:512
  ds_read_u16_d16_hi v37, v121 offset:640
  ds_read_u16_d16_hi v38, v121 offset:768
  ds_read_u16_d16_hi v39, v121 offset:896
  s_waitcnt lgkmcnt(7)
  v_fmac_f32 v32, v40, v20
  s_waitcnt lgkmcnt(6)
  v_fmac_f32 v33, v41, v21
  v_cvt_pk_bf16_f32 v12, v32, v33
  s_waitcnt lgkmcnt(5)
  v_fmac_f32 v34, v42, v22
  s_waitcnt lgkmcnt(4)
  v_fmac_f32 v35, v43, v23
  v_cvt_pk_bf16_f32 v13, v34, v35
  s_waitcnt lgkmcnt(3)
  v_fmac_f32 v36, v44, v24
  s_waitcnt lgkmcnt(2)
  v_fmac_f32 v37, v45, v25
  v_cvt_pk_bf16_f32 v14, v36, v37
  s_waitcnt lgkmcnt(1)
  v_fmac_f32 v38, v46, v26
  s_waitcnt lgkmcnt(0)
  v_fmac_f32 v39, v47, v27
  v_cvt_pk_bf16_f32 v15, v38, v39
  global_store_dwordx4 v123, v[12:15], s[28:29] sc1
  s_endpgm
L_exit:
  s_endpgm
.p2align 8
.type L_tables,@object
L_tables:
.quad 0x36400cc001b00000,0x27401350,0x4a5020d015a01410,0x4000081f0048b0,0xea034e029902820,0x8000100b1034a0,0x22b048f03d803c30,0xc0001846d02090
.quad 0x36800d3001f00040,0x130003032c00c80,0x4a90212015e01450,0x17000381ef04870,0xee0351002202860,0x1b000400ae03460,0x22f0490016303c70,0x1f0004846902050
.quad 0x36c00d702a000080,0x220006032800c40,0x4ad021603e101490,0x26000681eb04830,0xf103550026028a0,0x2a000700aa03420,0x2300494016703cb0,0x2e0007846502010
.quad 0x37300db02a4000c0,0x31000903b702740,0x3b70139013501350,0x35000984f603b70,0x4f60278013503b70,0x39000a03bb04f60,0x4fa04fa027404f60,0x3d000a84fa02780
.quad 0x11b0100004c02b30,0x1001803b702740,0x25a0241018d03f20,0x5001881bc04540,0x399038202ce00350,0x90019007d03150,0x4d804c3040f01740,0xd0019843a01d60
.quad 0x11f0104005302b70,0x12001b02fb00970,0x25e0245019203f60,0x16001b81b804500,0x122038602d100390,0x1a001c007903110,0x26304c7041001780,0x1e001c843601d20
.quad 0x3a00108005702bb0,0x23001e02f700930,0x4e10249019603fa0,0x27001e81b4044f0,0x126038a02d5003d0,0x2b001f0075030e0,0x26704cb0414017c0,0x2f001f843201cd0
.quad 0x3a4010c005b00400,0x30002104f601390,0x1350135013903b70,0x340021813902780,0x13503b7027804f60,0x380022027803bb0,0x27404f604fa01390,0x3c002283bb04fa0
.quad 0x27403b3008002e40,0x20030013501350,0x4d4027001c104250,0x60030840b01a70,0x39501310302006a0,0xa003102ca00660,0x25604ed044301ab0,0xe0031818904210
.quad 0x11703ac008402e80,0x110033004802e00,0x4d0026f01c504290,0x150033840701a30,0x391012e0306006e0,0x19003402c600620,0x25204e9044701af0,0x1d00348185019e0
.quad 0x11303a8008802ec0,0x2000360044005f0,0x4cf026b01c9042d0,0x240036840304180,0x38e012a030a00710,0x28003702c202d90,0x24d04e5044b01b00,0x2c00378181019a0
.quad 0x1390274008c02f30,0x330039027402740,0x27803b7013503b70,0x37003983b701350,0x3bb04f603b704f60,0x3b003a04f602740,0x4fa04fa04f604fa0,0x3f003a827803bb0
.quad 0x13503b70333009b0,0x30000027402740,0x227023c047201da0,0x7000083d401700,0xe600fd00b503190,0xb0001029500310,0x4a104ba01f404580,0xf0001815603ed0
.quad 0x360037b0337009f0,0x100003001702ac0,0x2230238047601de0,0x14000383d0016f0,0xe200f900b900a20,0x1800040291002e0,0x21e04b601f801e30,0x1c0004815203e90
.quad 0xdf0377033b03200,0x210006001302a80,0x4980234047a04610,0x25000683cf016b0,0x35900f500bd00a60,0x290007028e002a0,0x21a04b201fc01e70,0x2d0007814d03e50
.quad 0x27404f600c003240,0x320009013903b70,0x135013903b701350,0x360009827804f60,0x274027804f601350,0x3a000a03bb03bb0,0x3bb03bb013902740,0x3e000a84fa04fa0
.quad 0x3f803f803f803f80,0x3f803f803f803f80,0x3f353f5e3f773f80,0xbe85248d3e853f00,0x248d3f003f5e3f80,0xbf5ebf80bf5ebf00,0xbf35248d3f353f80,0x3f35a554bf35bf80
.quad 0xbf80bf003f003f80,0x3f003f803f00bf00,0xbf35bf5e3e853f80,0xbf77248d3f773f00,0xa554bf80248d3f80,0xa554bf80248d3f80,0x3f35bf5ebe853f80,0x3f77a554bf773f00
.quad 0x3f80bf00bf003f80,0xbf003f80bf00bf00,0x3f35a554bf353f80,0xbf35248d3f35bf80,0x248d3f00bf5e3f80,0x3f5ebf803f5ebf00,0xbf353f5ebf773f80,0x3e85a554be853f00
.quad 0xbf803f80bf803f80,0xbf803f80bf803f80,0x0,0x0,0x0,0x0,0x0,0x0
.quad 0x3f803f803f803f80,0x3f803f803f803f80,0xbf77bf5ebf35bf00,0xbf35bf5ebf77bf80,0x3f5e3f00a554bf00,0x248d3f003f5e3f80,0xbf35248d3f353f80,0x3f35a554bf35bf80
.quad 0x3f00bf00bf80bf00,0xbf80bf003f003f80,0xbe853f5e3f35bf00,0x3f353f5ebe85bf80,0xa554bf80248d3f80,0xa554bf80248d3f80,0x3e853f5ebf35bf00,0xbf353f5e3e85bf80
.quad 0xbf00bf003f80bf00,0x3f80bf00bf003f80,0x3f35a554bf353f80,0xbf35248d3f35bf80,0xbf5e3f00a554bf00,0x248d3f00bf5e3f80,0x3f77bf5e3f35bf00,0x3f35bf5e3f77bf80
.quad 0xbf803f80bf803f80,0xbf803f80bf803f80,0x0,0x0,0x0,0x0,0x0,0x0
.quad 0x3f803f803f803f80,0x3f803f803f803f80,0x3e85a554be85bf00,0x3f773f5e3f353f00,0xbf5ebf80bf5ebf00,0x3f5e3f00a554bf00,0xbf35248d3f353f80,0x3f35a554bf35bf80
.quad 0x3f003f803f00bf00,0x3f00bf00bf80bf00,0x3f77a554bf77bf00,0x3e85bf5ebf353f00,0xa554bf80248d3f80,0xa554bf80248d3f80,0xbf77248d3f77bf00,0xbe85bf5e3f353f00
.quad 0xbf003f80bf00bf00,0xbf00bf003f80bf00,0x3f35a554bf353f80,0xbf35248d3f35bf80,0x3f5ebf803f5ebf00,0xbf5e3f00a554bf00,0xbe85248d3e85bf00,0xbf773f5ebf353f00
.quad 0xbf803f80bf803f80,0xbf803f80bf803f80,0x0,0x0,0x0,0x0,0x0,0x0
.quad 0x0,0x0,0x0,0x0,0x0,0x0,0x0,0x0
.quad 0x0,0x0,0x0,0x0,0x0,0x0,0x0,0x0
.quad 0x0,0x0,0x0,0x0,0x0,0x0,0x0,0x0
.quad 0x0,0x0,0x0,0x0,0x0,0x0,0x0,0x0
.quad 0x8000800080008000,0x8000800080008000,0xbf35bf00be858000,0xbf77bf80bf77bf5e,0xbf80bf5ebf008000,0x3f00a50dbf00bf5e,0xbf35bf80bf358000,0x3f353f803f35a50d
.quad 0xa50dbf5ebf5e8000,0xbf5e80003f5e3f5e,0x3f35bf00bf778000,0xbe85bf80be853f5e,0x3f80a50dbf808000,0x3f80a50dbf808000,0x3f353f00bf778000,0xbe853f80be85bf5e
.quad 0x80003f5ebf5e8000,0xbf5e80003f5ebf5e,0xbf353f80bf358000,0x3f35bf803f35a50d,0xbf803f5ebf008000,0x3f00a50dbf003f5e,0xbf353f00be858000,0xbf773f80bf773f5e
.quad 0xa50d8000a50d8000,0xa50d8000a50d8000,0x0,0x0,0x0,0x0,0x0,0x0
.quad 0x8000800080008000,0x8000800080008000,0xbe85bf00bf35bf5e,0x3f353f003e85a50d,0x3f003f5e3f803f5e,0xbf80bf5ebf008000,0xbf35bf80bf358000,0x3f353f803f35a50d
.quad 0x3f5e3f5ea50dbf5e,0xa50dbf5ebf5e8000,0xbf77bf003f353f5e,0xbf353f003f77a50d,0x3f80a50dbf808000,0x3f80a50dbf808000,0xbf773f003f35bf5e,0xbf35bf003f77a50d
.quad 0x3f5ebf5e80003f5e,0x80003f5ebf5e8000,0xbf353f80bf358000,0x3f35bf803f35a50d,0x3f00bf5e3f80bf5e,0xbf803f5ebf008000,0xbe853f00bf353f5e,0x3f35bf003e85a50d
.quad 0xa50d8000a50d8000,0xa50d8000a50d8000,0x0,0x0,0x0,0x0,0x0,0x0
.quad 0x8000800080008000,0x8000800080008000,0x3f773f803f773f5e,0x3e853f003f353f5e,0x3f00a50dbf00bf5e,0x3f003f5e3f803f5e,0xbf35bf80bf358000,0x3f353f803f35a50d
.quad 0xbf5e80003f5e3f5e,0x3f5e3f5ea50dbf5e,0x3e853f803e85bf5e,0x3f773f00bf35bf5e,0x3f80a50dbf808000,0x3f80a50dbf808000,0x3e85bf803e853f5e,0x3f77bf00bf353f5e
.quad 0xbf5e80003f5ebf5e,0x3f5ebf5e80003f5e,0xbf353f80bf358000,0x3f35bf803f35a50d,0x3f00a50dbf003f5e,0x3f00bf5e3f80bf5e,0x3f77bf803f77bf5e,0x3e85bf003f35bf5e
.quad 0xa50d8000a50d8000,0xa50d8000a50d8000,0x0,0x0,0x0,0x0,0x0,0x0
.quad 0x0,0x0,0x0,0x0,0x0,0x0,0x0,0x0
.quad 0x0,0x0,0x0,0x0,0x0,0x0,0x0,0x0
.quad 0x0,0x0,0x0,0x0,0x0,0x0,0x0,0x0
.quad 0x0,0x0,0x0,0x0,0x0,0x0,0x0,0x0
.quad 0x3f8000003f800000,0x3f8000003f800000,0x3f7ffc1a3f800000,0x3f7fdce93f7ff067,0x3f7ff0673f800000,0x3f7f73af3f7fc1a0,0x3f7fdce93f800000,0x3f7ec46d3f7f73af
.quad 0x3f7fc1a03f800000,0x3f7dcf553f7f069e,0x3f7f9e8c3f800000,0x3f7c94a83f7e7a7a,0x3f7f73af3f800000,0x3f7b14be3f7dcf55,0x3f7f41093f800000,0x3f7950003f7d0543
.quad 0x3f7f069e3f800000,0x3f7746ea3f7c1c5c,0x3f7ec46d3f800000,0x3f74fa0b3f7b14be,0x3f7e7a7a3f800000,0x3f726a033f79ee89,0x3f7e28c63f800000,0x3f6f97883f78a9e0
.quad 0x3f7dcf553f800000,0x3f6c835e3f7746ea,0x3f7d6e283f800000,0x3f692e5f3f75c5d4,0x3f7d05433f800000,0x3f6599743f7426cb,0x3f7c94a83f800000,0x3f61c5983f726a03
.quad 0x3f8000003f800000,0x3f8000003f800000,0x3f7f9e8c3f7fc1a0,0x3f7f41093f7f73af,0x3f7e7a7a3f7f069e,0x3f7d05433f7dcf55,0x3f7c94a83f7dcf55,0x3f7950003f7b14be
.quad 0x3f79ee893f7c1c5c,0x3f7426cb3f7746ea,0x3f768a203f79ee89,0x3f6d91563f726a03,0x3f726a033f7746ea,0x3f6599743f6c835e,0x3f6d91563f7426cb,0x3f5c4b073f659974
.quad 0x3f6803ca3f708fb2,0x3f51b3f33f5db3d7,0x3f61c5983f6c835e,0x3f45e4033f54db31,0x3f5adb813f6803ca,0x3f38ecd83f4b1934,0x3f534aca3f631324,0x3f2ae1c93f407893
.quad 0x3f4b19343f5db3d7,0x3f1bd7ca3f3504f3,0x3f424cfe3f57e880,0x3f0be54a3f28cae3,0x3f38ecd83f51b3f3,0x3ef644293f1bd7ca,0x3f2effe83f4b1934,0x3ed34e563f0e39da
.quad 0x3f8000003f800000,0x3f8000003f800000,0x3f7ec46d3f7f069e,0x3f7e28c63f7e7a7a,0x3f7b14be3f7c1c5c,0x3f78a9e03f79ee89,0x3f74fa0b3f7746ea,0x3f6f97883f726a03
.quad 0x3f6c835e3f708fb2,0x3f6313243f6803ca,0x3f61c5983f6803ca,0x3f534aca3f5adb81,0x3f54db313f5db3d7,0x3f4078933f4b1934,0x3f45e4033f51b3f3,0x3f2ae1c93f38ecd8
.quad 0x3f3504f33f441b7d,0x3f12d5e83f248dbb,0x3f2267993f3504f3,0x3ef15aea3f0e39da,0x3f0e39da3f248dbb,0x3eb9917b3eec6a50,0x3ef15aea3f12d5e8,0x3e7e39c43eb9917b
.quad 0x3ec3ef153f000000,0x3e05a8a83e8483ee,0x3e94a0313ed8616c,0x3c32b7da3e1bc63c,0x3e47c5c23eaf1d44,0xbddef5993d32aa3e,0x3dc8bd363e8483ee,0xbe6886aebd85f213
.quad 0x3f8000003f800000,0x3f8000003f800000,0x3f7d6e283f7dcf55,0x3f7c94a83f7d0543,0x3f75c5d43f7746ea,0x3f726a033f7426cb,0x3f692e5f3f6c835e,0x3f61c5983f659974
.quad 0x3f57e8803f5db3d7,0x3f4b19343f51b3f3,0x3f424cfe3f4b1934,0x3f2effe83f38ecd8,0x3f28cae33f3504f3,0x3f0e39da3f1bd7ca,0x3f0be54a3f1bd7ca,0x3ed34e563ef64429
.quad 0x3ed8616c3f000000,0x3e8483ee3eaf1d44,0x3e94a0313ec3ef15,0x3dc8bd363e47c5c2,0x3e1bc63c3e8483ee,0xbd85f2133d32aa3e,0x3c32b7da3e05a8a8,0xbe6886aebddef599
.quad 0xbe05a8a8248d3132,0xbec3ef15be8483ee,0xbe89e6f1be05a8a8,0xbf072f74bece34d0,0xbece34d0be8483ee,0xbf28cae3bf098c78,0xbf072f74bec3ef15,0xbf45e403bf28cae3
.quad 0x0,0x0,0x3c32b7da00000000,0x3d0604723cb2b521,0x3cb2b52100000000,0x3d85f2133d32aa3e,0x3d06047200000000,0x3dc8bd363d85f213
.quad 0x3d32aa3e00000000,0x3e05a8a83db27eb6,0x3d5f4a9900000000,0x3e26ce123ddef599,0x3d85f21300000000,0x3e47c5c23e05a8a8,0x3d9c3ac600000000,0x3e6886ae3e1bc63c
.quad 0x3db27eb600000000,0x3e8483ee3e31d0d4,0x3dc8bd3600000000,0x3e94a0313e47c5c2,0x3ddef59900000000,0x3ea493b73e5da259,0x3df5273100000000,0x3eb45a1e3e7363ee
.quad 0x3e05a8a800000000,0x3ec3ef153e8483ee,0x3e10b9a600000000,0x3ed34e563e8f45c0,0x3e1bc63c00000000,0x3ee273aa3e99f61c,0x3e26ce1200000000,0x3ef15aea3ea493b7
.quad 0x0,0x0,0x3d5f4a993d32aa3e,0x3d9c3ac63d85f213,0x3ddef5993db27eb6,0x3e1bc63c3e05a8a8,0x3e26ce123e05a8a8,0x3e6886ae3e47c5c2
.quad 0x3e5da2593e31d0d4,0x3e99f61c3e8483ee,0x3e89e6f13e5da259,0x3ebec3303ea493b7,0x3ea493b73e8483ee,0x3ee273aa3ec3ef15,0x3ebec3303e99f61c,0x3f0269263ee273aa
.quad 0x3ed8616c3eaf1d44,0x3f12d5e83f000000,0x3ef15aea3ec3ef15,0x3f2267993f0e39da,0x3f04ce533ed8616c,0x3f3107003f1bd7ca,0x3f108a143eec6a50,0x3f3e9e4b3f28cae3
.quad 0x3f1bd7ca3f000000,0x3f4b19343f3504f3,0x3f26aed93f098c78,0x3f56651d3f407893,0x3f3107003f12d5e8,0x3f60712a3f4b1934,0x3f3ad85f3f1bd7ca,0x3f692e5f3f54db31
.quad 0x0,0x0,0x3dc8bd363db27eb6,0x3df527313ddef599,0x3e47c5c23e31d0d4,0x3e7363ee3e5da259,0x3e94a0313e8483ee,0x3eb45a1e3ea493b7
.quad 0x3ec3ef153eaf1d44,0x3eec6a503ed8616c,0x3ef15aea3ed8616c,0x3f108a143f04ce53,0x3f0e39da3f000000,0x3f28cae33f1bd7ca,0x3f2267993f12d5e8,0x3f3e9e4b3f310700
.quad 0x3f3504f33f248dbb,0x3f51b3f33f441b7d,0x3f45e4033f3504f3,0x3f61c5983f54db31,0x3f54db313f441b7d,0x3f6e98113f631324,0x3f61c5983f51b3f3,0x3f77fc2c3f6e9811
.quad 0x3f6c835e3f5db3d7,0x3f7dcf553f7746ea,0x3f74fa0b3f6803ca,0x3f7ffc1a3f7d0543,0x3f7b14be3f708fb2,0x3f7e7a7a3f7fc1a0,0x3f7ec46d3f7746ea,0x3f7950003f7f73af
.quad 0x0,0x0,0x3e10b9a63e05a8a8,0x3e26ce123e1bc63c,0x3e8f45c03e8483ee,0x3ea493b73e99f61c,0x3ed34e563ec3ef15,0x3ef15aea3ee273aa
.quad 0x3f098c783f000000,0x3f1bd7ca3f12d5e8,0x3f26aed93f1bd7ca,0x3f3ad85f3f310700,0x3f4078933f3504f3,0x3f54db313f4b1934,0x3f56651d3f4b1934,0x3f692e5f3f60712a
.quad 0x3f6803ca3f5db3d7,0x3f7746ea3f708fb2,0x3f74fa0b3f6c835e,0x3f7ec46d3f7b14be,0x3f7d05433f7746ea,0x3f7f73af3f7fc1a0,0x3f7ffc1a3f7dcf55,0x3f7950003f7e7a7a
.quad 0x3f7dcf553f800000,0x3f6c835e3f7746ea,0x3f768a203f7dcf55,0x3f5965503f6a51da,0x3f6a51da3f7746ea,0x3f4078933f57e880,0x3f5965503f6c835e,0x3f2267993f407893
.quad 0x3f8000003f800000,0x3f8000003f800000,0x3f7b9c623f7c1c5c,0x3f7a85753f7b14be,0x3f6e98113f708fb2,0x3f6a51da3f6c835e,0x3f5965503f5db3d7,0x3f5016b83f54db31
.quad 0x3f3cbe353f441b7d,0x3f2cf37b3f3504f3,0x3f199e453f248dbb,0x3f0269263f0e39da,0x3ee273aa3f000000,0x3ea493b73ec3ef15,0x3e89e6f13eaf1d44,0x3df527313e47c5c2
.quad 0x3db27eb63e31d0d4,0xbdb27eb6248d3132,0xbdc8bd36248d3132,0xbe94a031be47c5c2,0xbe8f45c0be31d0d4,0xbef64429bec3ef15,0xbee77284beaf1d44,0xbf26aed9bf0e39da
.quad 0xbf1bd7cabf000000,0xbf4b1934bf3504f3,0xbf3e9e4bbf248dbb,0xbf66d223bf54db31,0xbf5adb81bf441b7d,0xbf78a9e0bf6c835e,0xbf6f9788bf5db3d7,0xbf7fdce9bf7b14be
.quad 0x3f8000003f800000,0x3f8000003f800000,0x3f7950003f79ee89,0x3f77fc2c3f78a9e0,0x3f6599743f6803ca,0x3f60712a3f631324,0x3f45e4033f4b1934,0x3f3ad85f3f407893
.quad 0x3f1bd7ca3f248dbb,0x3f098c783f12d5e8,0x3ed34e563eec6a50,0x3e9f47573eb9917b,0x3e47c5c23e8483ee,0x3d85f2133e05a8a8,0xbd0604723d32aa3e,0xbe3cce2bbddef599
.quad 0xbe8483eebe31d0d4,0xbed8616cbeaf1d44,0xbef15aeabec3ef15,0xbf226799bf0e39da,0xbf28cae3bf12d5e8,0xbf4e7327bf3cbe35,0xbf5016b8bf3cbe35,0xbf6d9156bf60712a
.quad 0xbf6c835ebf5db3d7,0xbf7dcf55bf7746ea,0xbf7c94a8bf7426cb,0xbf7e28c6bf7ff067,0xbf7f73afbf7f069e,0xbf6e9811bf79ee89,0xbf74fa0bbf7dcf55,0xbf5016b8bf659974
.quad 0x3f8000003f800000,0x3f8000003f800000,0x3f7b9c623f7c1c5c,0x3f7a85753f7b14be,0x3f6e98113f708fb2,0x3f6a51da3f6c835e,0x3f5965503f5db3d7,0x3f5016b83f54db31
.quad 0x3f3cbe353f441b7d,0x3f2cf37b3f3504f3,0x3f199e453f248dbb,0x3f0269263f0e39da,0x3ee273aa3f000000,0x3ea493b73ec3ef15,0x3e89e6f13eaf1d44,0x3df527313e47c5c2
.quad 0x3db27eb63e31d0d4,0xbdb27eb6248d3132,0xbdc8bd36248d3132,0xbe94a031be47c5c2,0xbe8f45c0be31d0d4,0xbef64429bec3ef15,0xbee77284beaf1d44,0xbf26aed9bf0e39da
.quad 0xbf1bd7cabf000000,0xbf4b1934bf3504f3,0xbf3e9e4bbf248dbb,0xbf66d223bf54db31,0xbf5adb81bf441b7d,0xbf78a9e0bf6c835e,0xbf6f9788bf5db3d7,0xbf7fdce9bf7b14be
.quad 0x3f8000003f800000,0x3f8000003f800000,0x3f7950003f79ee89,0x3f77fc2c3f78a9e0,0x3f6599743f6803ca,0x3f60712a3f631324,0x3f45e4033f4b1934,0x3f3ad85f3f407893
.quad 0x3f1bd7ca3f248dbb,0x3f098c783f12d5e8,0x3ed34e563eec6a50,0x3e9f47573eb9917b,0x3e47c5c23e8483ee,0x3d85f2133e05a8a8,0xbd0604723d32aa3e,0xbe3cce2bbddef599
.quad 0xbe8483eebe31d0d4,0xbed8616cbeaf1d44,0xbef15aeabec3ef15,0xbf226799bf0e39da,0xbf28cae3bf12d5e8,0xbf4e7327bf3cbe35,0xbf5016b8bf3cbe35,0xbf6d9156bf60712a
.quad 0xbf6c835ebf5db3d7,0xbf7dcf55bf7746ea,0xbf7c94a8bf7426cb,0xbf7e28c6bf7ff067,0xbf7f73afbf7f069e,0xbf6e9811bf79ee89,0xbf74fa0bbf7dcf55,0xbf5016b8bf659974
.quad 0x0,0x0,0x3e3cce2b3e31d0d4,0x3e52b7433e47c5c2,0x3eb9917b3eaf1d44,0x3ece34d03ec3ef15,0x3f072f743f000000,0x3f151d423f0e39da
.quad 0x3f2cf37b3f248dbb,0x3f3cbe353f3504f3,0x3f4cc94c3f441b7d,0x3f5c4b073f54db31,0x3f6599743f5db3d7,0x3f726a033f6c835e,0x3f768a203f708fb2,0x3f7e28c63f7b14be
.quad 0x3f7f069e3f7c1c5c,0x3f7f069e3f800000,0x3f7ec46d3f800000,0x3f74fa0b3f7b14be,0x3f75c5d43f7c1c5c,0x3f60712a3f6c835e,0x3f6459c63f708fb2,0x3f424cfe3f54db31
.quad 0x3f4b19343f5db3d7,0x3f1bd7ca3f3504f3,0x3f2ae1c93f441b7d,0x3edd6dea3f0e39da,0x3f04ce533f248dbb,0x3e7363ee3ec3ef15,0x3eb45a1e3f000000,0x3d0604723e47c5c2
.quad 0x0,0x0,0x3e6886ae3e5da259,0x3e7e39c43e7363ee,0x3ee273aa3ed8616c,0x3ef644293eec6a50,0x3f2267993f1bd7ca,0x3f2effe83f28cae3
.quad 0x3f4b19343f441b7d,0x3f57e8803f51b3f3,0x3f692e5f3f631324,0x3f734c1c3f6e9811,0x3f7b14be3f7746ea,0x3f7f73af3f7dcf55,0x3f7fdce93f7fc1a0,0x3f7b9c623f7e7a7a
.quad 0x3f7746ea3f7c1c5c,0x3f6803ca3f708fb2,0x3f61c5983f6c835e,0x3f45e4033f54db31,0x3f4078933f51b3f3,0x3f1760123f2cf37b,0x3f151d423f2cf37b,0x3ebec3303ef64429
.quad 0x3ec3ef153f000000,0x3e05a8a83e8483ee,0x3e26ce123e99f61c,0xbdf527313cb2b521,0xbd85f2133db27eb6,0xbeb9917bbe5da259,0xbe94a031be05a8a8,0xbf151d42bee273aa
.quad 0x0,0x0,0x3e3cce2b3e31d0d4,0x3e52b7433e47c5c2,0x3eb9917b3eaf1d44,0x3ece34d03ec3ef15,0x3f072f743f000000,0x3f151d423f0e39da
.quad 0x3f2cf37b3f248dbb,0x3f3cbe353f3504f3,0x3f4cc94c3f441b7d,0x3f5c4b073f54db31,0x3f6599743f5db3d7,0x3f726a033f6c835e,0x3f768a203f708fb2,0x3f7e28c63f7b14be
.quad 0x3f7f069e3f7c1c5c,0x3f7f069e3f800000,0x3f7ec46d3f800000,0x3f74fa0b3f7b14be,0x3f75c5d43f7c1c5c,0x3f60712a3f6c835e,0x3f6459c63f708fb2,0x3f424cfe3f54db31
.quad 0x3f4b19343f5db3d7,0x3f1bd7ca3f3504f3,0x3f2ae1c93f441b7d,0x3edd6dea3f0e39da,0x3f04ce533f248dbb,0x3e7363ee3ec3ef15,0x3eb45a1e3f000000,0x3d0604723e47c5c2
.quad 0x0,0x0,0x3e6886ae3e5da259,0x3e7e39c43e7363ee,0x3ee273aa3ed8616c,0x3ef644293eec6a50,0x3f2267993f1bd7ca,0x3f2effe83f28cae3
.quad 0x3f4b19343f441b7d,0x3f57e8803f51b3f3,0x3f692e5f3f631324,0x3f734c1c3f6e9811,0x3f7b14be3f7746ea,0x3f7f73af3f7dcf55,0x3f7fdce93f7fc1a0,0x3f7b9c623f7e7a7a
.quad 0x3f7746ea3f7c1c5c,0x3f6803ca3f708fb2,0x3f61c5983f6c835e,0x3f45e4033f54db31,0x3f4078933f51b3f3,0x3f1760123f2cf37b,0x3f151d423f2cf37b,0x3ebec3303ef64429
.quad 0x3ec3ef153f000000,0x3e05a8a83e8483ee,0x3e26ce123e99f61c,0xbdf527313cb2b521,0xbd85f2133db27eb6,0xbeb9917bbe5da259,0xbe94a031be05a8a8,0xbf151d42bee273aa
.quad 0x3f8000003f80,0x3f8000003f80,0x3f8080003f808000,0x3f8080003f808000,0x3e853f7700003f80,0x3f353f353f003f5e,0x3f77be853f808000,0x3f35bf353f5ebf00
.quad 0x3f003f5e00003f80,0x3f80248d3f5e3f00,0x3f5ebf003f808000,0x248dbf803f00bf5e,0x3f353f3500003f80,0x3f35bf353f80248d,0x3f35bf353f808000,0xbf35bf35248dbf80
.quad 0x3f5e3f0000003f80,0x250dbf803f5ebf00,0x3f00bf5e3f808000,0xbf80a50dbf00bf5e,0x3f773e8500003f80,0xbf35bf353f00bf5e,0x3e85bf773f808000,0xbf353f35bf5ebf00
.quad 0x3f80248d00003f80,0xbf80a554250dbf80,0x248dbf803f808000,0xa5543f80bf80a50d,0x3f77be8500003f80,0xbf353f35bf00bf5e,0xbe85bf773f808000,0x3f353f35bf5e3f00
.quad 0x3f8000003f80,0x3f8000003f80,0x3f8080003f808000,0x3f8080003f808000,0x3f773e853f5e3f00,0x3f77be853f80248d,0x3e85bf773f00bf5e,0xbe85bf77248dbf80
.quad 0x3f00bf5e3f5ebf00,0xbf00bf5e250dbf80,0xbf5ebf00bf00bf5e,0xbf5e3f00bf80a50d,0xbf35bf35250dbf80,0xbf353f35bf80a554,0xbf353f35bf80a50d,0x3f353f35a5543f80
.quad 0xbf5e3f00bf5ebf00,0x3f5e3f0000003f80,0x3f003f5ebf003f5e,0x3f00bf5e3f808000,0x3e853f77bf5e3f00,0x3e85bf773f80248d,0x3f77be853f003f5e,0xbf77be85248dbf80
.quad 0x3f80248d00003f80,0xbf80a554250dbf80,0x248dbf803f808000,0xa5543f80bf80a50d,0x3e85bf773f5e3f00,0x3e853f77bf80a554,0xbf77be853f00bf5e,0x3f77be85a5543f80
.quad 0x3f8000003f80,0x3f8000003f80,0x3f8080003f808000,0x3f8080003f808000,0x3f35bf353f5ebf00,0x3e85bf773f00bf5e,0xbf35bf35bf00bf5e,0xbf77be85bf5ebf00
.quad 0xbf80a554bf5ebf00,0xbf003f5ebf5e3f00,0xa5543f80bf003f5e,0x3f5e3f003f003f5e,0x3f353f3500003f80,0x3f35bf353f80248d,0x3f35bf353f808000,0xbf35bf35248dbf80
.quad 0x250dbf803f5ebf00,0xbf5e3f00bf5ebf00,0xbf80a50dbf00bf5e,0x3f003f5ebf003f5e,0xbf353f35bf5ebf00,0x3f77be853f003f5e,0x3f353f35bf003f5e,0xbe85bf773f5ebf00
.quad 0x3f80248d00003f80,0xbf80a554250dbf80,0x248dbf803f808000,0xa5543f80bf80a50d,0xbf35bf353f5ebf00,0x3f773e85bf003f5e,0xbf353f35bf00bf5e,0x3e85bf773f5e3f00
.quad 0x3f8000003f80,0x3f8000003f80,0x3f8080003f808000,0x3f8080003f808000,0xbe85bf77250dbf80,0xbf35bf35bf00bf5e,0xbf773e85bf80a50d,0xbf353f35bf5e3f00
.quad 0x3f003f5e00003f80,0x3f80248d3f5e3f00,0x3f5ebf003f808000,0x248dbf803f00bf5e,0xbf35bf35250dbf80,0xbf353f35bf80a554,0xbf353f35bf80a50d,0x3f353f35a5543f80
.quad 0x3f5e3f0000003f80,0x250dbf803f5ebf00,0x3f00bf5e3f808000,0xbf80a50dbf00bf5e,0xbf77be85250dbf80,0x3f353f35bf003f5e,0xbe853f77bf80a50d,0x3f35bf353f5e3f00
.quad 0x3f80248d00003f80,0xbf80a554250dbf80,0x248dbf803f808000,0xa5543f80bf80a50d,0xbf773e85250dbf80,0x3f35bf353f003f5e,0x3e853f77bf80a50d,0xbf35bf353f5ebf00
.quad 0x3f8000003f80,0x3f8000003f80,0x3f8080003f808000,0x3f8080003f808000,0xbf77be85bf5ebf00,0xbf773e85bf80a554,0xbe853f77bf003f5e,0x3e853f77a5543f80
.quad 0x3f00bf5e3f5ebf00,0xbf00bf5e250dbf80,0xbf5ebf00bf00bf5e,0xbf5e3f00bf80a50d,0x3f353f3500003f80,0x3f35bf353f80248d,0x3f35bf353f808000,0xbf35bf35248dbf80
.quad 0xbf5e3f00bf5ebf00,0x3f5e3f0000003f80,0x3f003f5ebf003f5e,0x3f00bf5e3f808000,0xbe85bf773f5ebf00,0xbe853f77bf80a554,0xbf773e85bf00bf5e,0x3f773e85a5543f80
.quad 0x3f80248d00003f80,0xbf80a554250dbf80,0x248dbf803f808000,0xa5543f80bf80a50d,0xbe853f77bf5ebf00,0xbe85bf773f80248d,0x3f773e85bf003f5e,0xbf773e85248dbf80
.quad 0x3f8000003f80,0x3f8000003f80,0x3f8080003f808000,0x3f8080003f808000,0xbf353f35bf5e3f00,0xbe853f77bf003f5e,0x3f353f353f003f5e,0x3f773e853f5e3f00
.quad 0xbf80a554bf5ebf00,0xbf003f5ebf5e3f00,0xa5543f80bf003f5e,0x3f5e3f003f003f5e,0xbf35bf35250dbf80,0xbf353f35bf80a554,0xbf353f35bf80a50d,0x3f353f35a5543f80
.quad 0x250dbf803f5ebf00,0xbf5e3f00bf5ebf00,0xbf80a50dbf00bf5e,0x3f003f5ebf003f5e,0x3f35bf353f5e3f00,0xbf773e85bf00bf5e,0xbf35bf353f00bf5e,0x3e853f77bf5e3f00
.quad 0x3f80248d00003f80,0xbf80a554250dbf80,0x248dbf803f808000,0xa5543f80bf80a50d,0x3f353f35bf5e3f00,0xbf77be853f00bf5e,0x3f35bf353f003f5e,0xbe853f77bf5ebf00
.quad 0x0,0x0,0x0,0x0,0x0,0x0,0x0,0x0
.quad 0x0,0x0,0x0,0x0,0x0,0x0,0x0,0x0
.quad 0x0,0x0,0x0,0x0,0x0,0x0,0x0,0x0
.quad 0x0,0x0,0x0,0x0,0x0,0x0,0x0,0x0
.quad 0x0,0x0,0x0,0x0,0x0,0x0,0x0,0x0
.quad 0x0,0x0,0x0,0x0,0x0,0x0,0x0,0x0
.quad 0x0,0x0,0x0,0x0,0x0,0x0,0x0,0x0
.quad 0x0,0x0,0x0,0x0,0x0,0x0,0x0,0x0
.quad 0x0,0x0,0x0,0x0,0x0,0x0,0x0,0x0
.quad 0x0,0x0,0x0,0x0,0x0,0x0,0x0,0x0
.quad 0x0,0x0,0x0,0x0,0x0,0x0,0x0,0x0
.quad 0x0,0x0,0x0,0x0,0x0,0x0,0x0,0x0
.quad 0x0,0x0,0x0,0x0,0x0,0x0,0x0,0x0
.quad 0x0,0x0,0x0,0x0,0x0,0x0,0x0,0x0
.quad 0x0,0x0,0x0,0x0,0x0,0x0,0x0,0x0
.quad 0x0,0x0,0x0,0x0,0x0,0x0,0x0,0x0
.quad 0x3f8000003f80,0x3f8000003f80,0x3f8080003f808000,0x3f8080003f808000,0xbf77be85bf5ebf00,0xbf773e85bf80a554,0xbe853f77bf003f5e,0x3e853f77a5543f80
.quad 0x3f00bf5e3f5ebf00,0xbf00bf5e250dbf80,0xbf5ebf00bf00bf5e,0xbf5e3f00bf80a50d,0x3f353f3500003f80,0x3f35bf353f80248d,0x3f35bf353f808000,0xbf35bf35248dbf80
.quad 0xbf5e3f00bf5ebf00,0x3f5e3f0000003f80,0x3f003f5ebf003f5e,0x3f00bf5e3f808000,0xbe85bf773f5ebf00,0xbe853f77bf80a554,0xbf773e85bf00bf5e,0x3f773e85a5543f80
.quad 0x3f80248d00003f80,0xbf80a554250dbf80,0x248dbf803f808000,0xa5543f80bf80a50d,0xbe853f77bf5ebf00,0xbe85bf773f80248d,0x3f773e85bf003f5e,0xbf773e85248dbf80
.quad 0x3f8000003f80,0x3f8000003f80,0x3f8080003f808000,0x3f8080003f808000,0xbf353f35bf5e3f00,0xbe853f77bf003f5e,0x3f353f353f003f5e,0x3f773e853f5e3f00
.quad 0xbf80a554bf5ebf00,0xbf003f5ebf5e3f00,0xa5543f80bf003f5e,0x3f5e3f003f003f5e,0xbf35bf35250dbf80,0xbf353f35bf80a554,0xbf353f35bf80a50d,0x3f353f35a5543f80
.quad 0x250dbf803f5ebf00,0xbf5e3f00bf5ebf00,0xbf80a50dbf00bf5e,0x3f003f5ebf003f5e,0x3f35bf353f5e3f00,0xbf773e85bf00bf5e,0xbf35bf353f00bf5e,0x3e853f77bf5e3f00
.quad 0x3f80248d00003f80,0xbf80a554250dbf80,0x248dbf803f808000,0xa5543f80bf80a50d,0x3f353f35bf5e3f00,0xbf77be853f00bf5e,0x3f35bf353f003f5e,0xbe853f77bf5ebf00
.quad 0x3f5ebf0000003f80,0x3f80bf5ebf00,0xbf00bf5e3f808000,0x3f808000bf003f5e,0x3f35bf3500003f80,0x3f353f35bf80a554,0xbf35bf353f808000,0x3f35bf35a5543f80
.quad 0x3f00bf5e00003f80,0x3f80248dbf5e3f00,0xbf5ebf003f808000,0x248dbf803f003f5e,0x3e85bf7700003f80,0x3f35bf35bf003f5e,0xbf77be853f808000,0xbf35bf353f5e3f00
.quad 0x250dbf8000003f80,0x250dbf8000003f80,0x3f80250dbf800000,0x3f80250dbf800000,0xbe85bf7700003f80,0xbf35bf353f003f5e,0x3f77be85bf800000,0x3f35bf35bf5e3f00
.quad 0xbf00bf5e00003f80,0xbf80a5543f5e3f00,0x3f5ebf00bf800000,0x2554bf80bf003f5e,0xbf35bf3500003f80,0xbf353f353f80248d,0x3f35bf35bf800000,0xbf35bf35a48d3f80
.quad 0xbf5ebf003f5ebf00,0x3f5ebf0000003f80,0xbf003f5ebf00bf5e,0xbf00bf5e3f808000,0xbf353f35250dbf80,0xbf35bf353f80248d,0x3f353f35bf80a50d,0xbf353f35248dbf80
.quad 0x3f003f5ebf5ebf00,0xbf003f5e250dbf80,0x3f5ebf00bf003f5e,0x3f5e3f00bf80a50d,0x3f77be85bf5e3f00,0x3f773e85bf80a554,0xbe85bf773f003f5e,0x3e85bf77a5543f80
.quad 0x250dbf8000003f80,0x250dbf8000003f80,0x3f80250dbf800000,0x3f80250dbf800000,0xbf77be853f5e3f00,0xbf773e853f80248d,0x3e85bf77bf003f5e,0xbe85bf77a48d3f80
.quad 0xbf003f5e3f5ebf00,0x3f003f5e250dbf80,0xbf5ebf003f003f5e,0xbf5e3f003f80250d,0x3f353f35250dbf80,0x3f35bf35bf80a554,0xbf353f353f80250d,0x3f353f352554bf80
.quad 0x3f80bf5ebf00,0xbf5ebf003f5ebf00,0x3f808000bf003f5e,0xbf003f5ebf00bf5e,0x3f35bf3500003f80,0x3f353f35bf80a554,0xbf35bf353f808000,0x3f35bf35a5543f80
.quad 0xbf80a5543f5ebf00,0xbf00bf5e3f5e3f00,0xa5543f80bf00bf5e,0xbf5e3f003f00bf5e,0x3f353f35bf5ebf00,0x3e853f77bf00bf5e,0x3f35bf35bf003f5e,0x3f77be85bf5e3f00
.quad 0x250dbf8000003f80,0x250dbf8000003f80,0x3f80250dbf800000,0x3f80250dbf800000,0xbf353f353f5ebf00,0xbe853f773f00bf5e,0xbf35bf353f003f5e,0xbf77be853f5e3f00
.quad 0x3f80248dbf5ebf00,0x3f00bf5ebf5e3f00,0xa48d3f803f00bf5e,0x3f5e3f00bf00bf5e,0xbf35bf3500003f80,0xbf353f353f80248d,0x3f35bf35bf800000,0xbf35bf35a48d3f80
.quad 0x3f5ebf0000003f80,0x3f80bf5ebf00,0xbf00bf5e3f808000,0x3f808000bf003f5e,0xbf353f35250dbf80,0xbf35bf353f80248d,0x3f353f35bf80a50d,0xbf353f35248dbf80
.quad 0x3f00bf5e00003f80,0x3f80248dbf5e3f00,0xbf5ebf003f808000,0x248dbf803f003f5e,0xbe853f77250dbf80,0xbf353f353f00bf5e,0x3f773e85bf80a50d,0x3f353f35bf5ebf00
.quad 0x250dbf8000003f80,0x250dbf8000003f80,0x3f80250dbf800000,0x3f80250dbf800000,0x3e853f77250dbf80,0x3f353f35bf00bf5e,0xbf773e853f80250d,0xbf353f353f5ebf00
.quad 0xbf00bf5e00003f80,0xbf80a5543f5e3f00,0x3f5ebf00bf800000,0x2554bf80bf003f5e,0x3f353f35250dbf80,0x3f35bf35bf80a554,0xbf353f353f80250d,0x3f353f352554bf80
.quad 0xbf5ebf003f5ebf00,0x3f5ebf0000003f80,0xbf003f5ebf00bf5e,0xbf00bf5e3f808000,0x3f35bf3500003f80,0x3f353f35bf80a554,0xbf35bf353f808000,0x3f35bf35a5543f80
.quad 0x3f003f5ebf5ebf00,0xbf003f5e250dbf80,0x3f5ebf00bf003f5e,0x3f5e3f00bf80a50d,0xbf773e853f5ebf00,0xbf77be853f80248d,0x3e853f77bf00bf5e,0xbe853f77248dbf80
.quad 0x250dbf8000003f80,0x250dbf8000003f80,0x3f80250dbf800000,0x3f80250dbf800000,0x3f773e85bf5ebf00,0x3f77be85bf80a554,0xbe853f773f00bf5e,0x3e853f772554bf80
.quad 0xbf003f5e3f5ebf00,0x3f003f5e250dbf80,0xbf5ebf003f003f5e,0xbf5e3f003f80250d,0xbf35bf3500003f80,0xbf353f353f80248d,0x3f35bf35bf800000,0xbf35bf35a48d3f80
.quad 0x3f80bf5ebf00,0xbf5ebf003f5ebf00,0x3f808000bf003f5e,0xbf003f5ebf00bf5e,0xbf353f35250dbf80,0xbf35bf353f80248d,0x3f353f35bf80a50d,0xbf353f35248dbf80
.quad 0xbf80a5543f5ebf00,0xbf00bf5e3f5e3f00,0xa5543f80bf00bf5e,0xbf5e3f003f00bf5e,0xbf35bf353f5e3f00,0xbe85bf773f003f5e,0xbf353f353f00bf5e,0xbf773e853f5ebf00
.quad 0x250dbf8000003f80,0x250dbf8000003f80,0x3f80250dbf800000,0x3f80250dbf800000,0x3f35bf35bf5e3f00,0x3e85bf77bf003f5e,0x3f353f35bf00bf5e,0x3f773e85bf5ebf00
.quad 0x3f80248dbf5ebf00,0x3f00bf5ebf5e3f00,0xa48d3f803f00bf5e,0x3f5e3f00bf00bf5e,0x3f353f35250dbf80,0x3f35bf35bf80a554,0xbf353f353f80250d,0x3f353f352554bf80
.quad 0x0,0x0,0x0,0x0,0x0,0x0,0x0,0x0
.quad 0x0,0x0,0x0,0x0,0x0,0x0,0x0,0x0
.quad 0x0,0x0,0x0,0x0,0x0,0x0,0x0,0x0
.quad 0x0,0x0,0x0,0x0,0x0,0x0,0x0,0x0
.quad 0x0,0x0,0x0,0x0,0x0,0x0,0x0,0x0
.quad 0x0,0x0,0x0,0x0,0x0,0x0,0x0,0x0
.quad 0x0,0x0,0x0,0x0,0x0,0x0,0x0,0x0
.quad 0x0,0x0,0x0,0x0,0x0,0x0,0x0,0x0
.quad 0x0,0x0,0x0,0x0,0x0,0x0,0x0,0x0
.quad 0x0,0x0,0x0,0x0,0x0,0x0,0x0,0x0
.quad 0x0,0x0,0x0,0x0,0x0,0x0,0x0,0x0
.quad 0x0,0x0,0x0,0x0,0x0,0x0,0x0,0x0
.quad 0x0,0x0,0x0,0x0,0x0,0x0,0x0,0x0
.quad 0x0,0x0,0x0,0x0,0x0,0x0,0x0,0x0
.quad 0x0,0x0,0x0,0x0,0x0,0x0,0x0,0x0
.quad 0x0,0x0,0x0,0x0,0x0,0x0,0x0,0x0
.quad 0xbf5ebf003f5ebf00,0x3f5ebf0000003f80,0xbf003f5ebf00bf5e,0xbf00bf5e3f808000,0x3f35bf3500003f80,0x3f353f35bf80a554,0xbf35bf353f808000,0x3f35bf35a5543f80
.quad 0x3f003f5ebf5ebf00,0xbf003f5e250dbf80,0x3f5ebf00bf003f5e,0x3f5e3f00bf80a50d,0xbf773e853f5ebf00,0xbf77be853f80248d,0x3e853f77bf00bf5e,0xbe853f77248dbf80
.quad 0x250dbf8000003f80,0x250dbf8000003f80,0x3f80250dbf800000,0x3f80250dbf800000,0x3f773e85bf5ebf00,0x3f77be85bf80a554,0xbe853f773f00bf5e,0x3e853f772554bf80
.quad 0xbf003f5e3f5ebf00,0x3f003f5e250dbf80,0xbf5ebf003f003f5e,0xbf5e3f003f80250d,0xbf35bf3500003f80,0xbf353f353f80248d,0x3f35bf35bf800000,0xbf35bf35a48d3f80
.quad 0x3f80bf5ebf00,0xbf5ebf003f5ebf00,0x3f808000bf003f5e,0xbf003f5ebf00bf5e,0xbf353f35250dbf80,0xbf35bf353f80248d,0x3f353f35bf80a50d,0xbf353f35248dbf80
.quad 0xbf80a5543f5ebf00,0xbf00bf5e3f5e3f00,0xa5543f80bf00bf5e,0xbf5e3f003f00bf5e,0xbf35bf353f5e3f00,0xbe85bf773f003f5e,0xbf353f353f00bf5e,0xbf773e853f5ebf00
.quad 0x250dbf8000003f80,0x250dbf8000003f80,0x3f80250dbf800000,0x3f80250dbf800000,0x3f35bf35bf5e3f00,0x3e85bf77bf003f5e,0x3f353f35bf00bf5e,0x3f773e85bf5ebf00
.quad 0x3f80248dbf5ebf00,0x3f00bf5ebf5e3f00,0xa48d3f803f00bf5e,0x3f5e3f00bf00bf5e,0x3f353f35250dbf80,0x3f35bf35bf80a554,0xbf353f353f80250d,0x3f353f352554bf80
.quad 0xbf5ebf0000003f80,0x3f803f5ebf00,0x3f00bf5ebf800000,0xbf8000003f003f5e,0xbf77be8500003f80,0x3f353f353f00bf5e,0x3e85bf77bf800000,0xbf353f353f5e3f00
.quad 0xbf80a55400003f80,0x3f80248d250dbf80,0x2554bf80bf800000,0xa48d3f803f80250d,0xbf773e8500003f80,0x3f35bf35bf00bf5e,0xbe85bf77bf800000,0x3f353f353f5ebf00
.quad 0xbf5e3f0000003f80,0x250dbf80bf5ebf00,0xbf00bf5ebf800000,0x3f80250d3f00bf5e,0xbf353f3500003f80,0xbf35bf35bf80a554,0xbf35bf35bf800000,0x3f35bf352554bf80
.quad 0xbf003f5e00003f80,0xbf80a554bf5e3f00,0xbf5ebf00bf800000,0x2554bf80bf00bf5e,0xbe853f7700003f80,0xbf353f35bf003f5e,0xbf77be85bf800000,0xbf35bf35bf5ebf00
.quad 0x3f5ebf00bf5ebf00,0xbf5ebf0000003f80,0x3f003f5e3f00bf5e,0x3f00bf5ebf800000,0xbe85bf77bf5e3f00,0xbe853f773f80248d,0x3f77be85bf00bf5e,0xbf77be85a48d3f80
.quad 0xbf80a55400003f80,0x3f80248d250dbf80,0x2554bf80bf800000,0xa48d3f803f80250d,0xbe853f773f5e3f00,0xbe85bf77bf80a554,0xbf77be85bf003f5e,0x3f77be852554bf80
.quad 0x3f5e3f003f5ebf00,0xbf5e3f0000003f80,0xbf003f5e3f003f5e,0xbf00bf5ebf800000,0x3f35bf35250dbf80,0x3f353f353f80248d,0x3f353f353f80250d,0xbf353f35a48d3f80
.quad 0xbf00bf5ebf5ebf00,0x3f00bf5e250dbf80,0x3f5ebf003f00bf5e,0x3f5e3f003f80250d,0xbf773e85bf5e3f00,0xbf77be85bf80a554,0xbe85bf77bf00bf5e,0x3e85bf772554bf80
.quad 0x3f803f5ebf00,0x3f5ebf00bf5ebf00,0xbf8000003f003f5e,0x3f003f5e3f00bf5e,0x3f35bf35bf5ebf00,0xbf773e853f003f5e,0x3f353f353f00bf5e,0xbe85bf77bf5e3f00
.quad 0xbf80a55400003f80,0x3f80248d250dbf80,0x2554bf80bf800000,0xa48d3f803f80250d,0x3f353f353f5ebf00,0xbf77be85bf003f5e,0xbf353f353f003f5e,0x3e85bf77bf5ebf00
.quad 0x250dbf80bf5ebf00,0x3f5e3f003f5ebf00,0x3f80250d3f00bf5e,0xbf003f5e3f003f5e,0xbf353f3500003f80,0xbf35bf35bf80a554,0xbf35bf35bf800000,0x3f35bf352554bf80
.quad 0x3f80248d3f5ebf00,0x3f003f5e3f5e3f00,0xa48d3f803f003f5e,0xbf5e3f00bf003f5e,0xbf35bf35bf5ebf00,0xbe85bf77bf00bf5e,0x3f35bf353f00bf5e,0x3f77be853f5ebf00
.quad 0xbf5ebf0000003f80,0x3f803f5ebf00,0x3f00bf5ebf800000,0xbf8000003f003f5e,0x3f773e85250dbf80,0xbf35bf35bf003f5e,0xbe853f773f80250d,0x3f35bf35bf5ebf00
.quad 0xbf80a55400003f80,0x3f80248d250dbf80,0x2554bf80bf800000,0xa48d3f803f80250d,0x3f77be85250dbf80,0xbf353f353f003f5e,0x3e853f773f80250d,0xbf35bf35bf5e3f00
.quad 0xbf5e3f0000003f80,0x250dbf80bf5ebf00,0xbf00bf5ebf800000,0x3f80250d3f00bf5e,0x3f35bf35250dbf80,0x3f353f353f80248d,0x3f353f353f80250d,0xbf353f35a48d3f80
.quad 0xbf003f5e00003f80,0xbf80a554bf5e3f00,0xbf5ebf00bf800000,0x2554bf80bf00bf5e,0x3e85bf77250dbf80,0x3f35bf353f00bf5e,0x3f773e853f80250d,0x3f353f353f5e3f00
.quad 0x3f5ebf00bf5ebf00,0xbf5ebf0000003f80,0x3f003f5e3f00bf5e,0x3f00bf5ebf800000,0x3e853f773f5ebf00,0x3e85bf77bf80a554,0xbf773e853f003f5e,0x3f773e852554bf80
.quad 0xbf80a55400003f80,0x3f80248d250dbf80,0x2554bf80bf800000,0xa48d3f803f80250d,0x3e85bf77bf5ebf00,0x3e853f773f80248d,0x3f773e853f00bf5e,0xbf773e85a48d3f80
.quad 0x3f5e3f003f5ebf00,0xbf5e3f0000003f80,0xbf003f5e3f003f5e,0xbf00bf5ebf800000,0xbf353f3500003f80,0xbf35bf35bf80a554,0xbf35bf35bf800000,0x3f35bf352554bf80
.quad 0xbf00bf5ebf5ebf00,0x3f00bf5e250dbf80,0x3f5ebf003f00bf5e,0x3f5e3f003f80250d,0x3f77be853f5ebf00,0x3f773e853f80248d,0x3e853f773f003f5e,0xbe853f77a48d3f80
.quad 0x3f803f5ebf00,0x3f5ebf00bf5ebf00,0xbf8000003f003f5e,0x3f003f5e3f00bf5e,0xbf353f353f5e3f00,0x3f77be85bf00bf5e,0xbf35bf35bf003f5e,0x3e853f773f5ebf00
.quad 0xbf80a55400003f80,0x3f80248d250dbf80,0x2554bf80bf800000,0xa48d3f803f80250d,0xbf35bf35bf5e3f00,0x3f773e853f00bf5e,0x3f35bf35bf00bf5e,0xbe853f773f5e3f00
.quad 0x250dbf80bf5ebf00,0x3f5e3f003f5ebf00,0x3f80250d3f00bf5e,0xbf003f5e3f003f5e,0x3f35bf35250dbf80,0x3f353f353f80248d,0x3f353f353f80250d,0xbf353f35a48d3f80
.quad 0x3f80248d3f5ebf00,0x3f003f5e3f5e3f00,0xa48d3f803f003f5e,0xbf5e3f00bf003f5e,0x3f353f353f5e3f00,0x3e853f773f003f5e,0xbf353f35bf003f5e,0xbf773e85bf5e3f00
.quad 0x0,0x0,0x0,0x0,0x0,0x0,0x0,0x0
.quad 0x0,0x0,0x0,0x0,0x0,0x0,0x0,0x0
.quad 0x0,0x0,0x0,0x0,0x0,0x0,0x0,0x0
.quad 0x0,0x0,0x0,0x0,0x0,0x0,0x0,0x0
.quad 0x0,0x0,0x0,0x0,0x0,0x0,0x0,0x0
.quad 0x0,0x0,0x0,0x0,0x0,0x0,0x0,0x0
.quad 0x0,0x0,0x0,0x0,0x0,0x0,0x0,0x0
.quad 0x0,0x0,0x0,0x0,0x0,0x0,0x0,0x0
.quad 0x0,0x0,0x0,0x0,0x0,0x0,0x0,0x0
.quad 0x0,0x0,0x0,0x0,0x0,0x0,0x0,0x0
.quad 0x0,0x0,0x0,0x0,0x0,0x0,0x0,0x0
.quad 0x0,0x0,0x0,0x0,0x0,0x0,0x0,0x0
.quad 0x0,0x0,0x0,0x0,0x0,0x0,0x0,0x0
.quad 0x0,0x0,0x0,0x0,0x0,0x0,0x0,0x0
.quad 0x0,0x0,0x0,0x0,0x0,0x0,0x0,0x0
.quad 0x0,0x0,0x0,0x0,0x0,0x0,0x0,0x0
.quad 0x3f5ebf00bf5ebf00,0xbf5ebf0000003f80,0x3f003f5e3f00bf5e,0x3f00bf5ebf800000,0x3e853f773f5ebf00,0x3e85bf77bf80a554,0xbf773e853f003f5e,0x3f773e852554bf80
.quad 0xbf80a55400003f80,0x3f80248d250dbf80,0x2554bf80bf800000,0xa48d3f803f80250d,0x3e85bf77bf5ebf00,0x3e853f773f80248d,0x3f773e853f00bf5e,0xbf773e85a48d3f80
.quad 0x3f5e3f003f5ebf00,0xbf5e3f0000003f80,0xbf003f5e3f003f5e,0xbf00bf5ebf800000,0xbf353f3500003f80,0xbf35bf35bf80a554,0xbf35bf35bf800000,0x3f35bf352554bf80
.quad 0xbf00bf5ebf5ebf00,0x3f00bf5e250dbf80,0x3f5ebf003f00bf5e,0x3f5e3f003f80250d,0x3f77be853f5ebf00,0x3f773e853f80248d,0x3e853f773f003f5e,0xbe853f77a48d3f80
.quad 0x3f803f5ebf00,0x3f5ebf00bf5ebf00,0xbf8000003f003f5e,0x3f003f5e3f00bf5e,0xbf353f353f5e3f00,0x3f77be85bf00bf5e,0xbf35bf35bf003f5e,0x3e853f773f5ebf00
.quad 0xbf80a55400003f80,0x3f80248d250dbf80,0x2554bf80bf800000,0xa48d3f803f80250d,0xbf35bf35bf5e3f00,0x3f773e853f00bf5e,0x3f35bf35bf00bf5e,0xbe853f773f5e3f00
.quad 0x250dbf80bf5ebf00,0x3f5e3f003f5ebf00,0x3f80250d3f00bf5e,0xbf003f5e3f003f5e,0x3f35bf35250dbf80,0x3f353f353f80248d,0x3f353f353f80250d,0xbf353f35a48d3f80
.quad 0x3f80248d3f5ebf00,0x3f003f5e3f5e3f00,0xa48d3f803f003f5e,0xbf5e3f00bf003f5e,0x3f353f353f5e3f00,0x3e853f773f003f5e,0xbf353f35bf003f5e,0xbf773e85bf5e3f00
.quad 0x8b001658000076e0,0x15382800890088e0,0x8b200c18102066c0,0xaf82a00890488c0,0x8b4001d8204056a0,0xb82810890888a0,0x8b607a9830604680,0x79782a10890c8880
.quad 0x8b801650408074e0,0x1530282089108860,0x8ba00c1050a064c0,0xaf02a2089148840,0x8bc001d060c054a0,0xb0283089188820,0x8be07a9070e04480,0x79702a30891c8800
.quad 0x8c00164802003460,0x15282840898087e0,0x8c200c0812202440,0xae82a40898487c0,0x8c4001c822401420,0xa82850898887a0,0x8c607a8832600400,0x79682a50898c8780
.quad 0x8c80164042803660,0x1520286089908760,0x8ca00c0052a02640,0xae02a6089948740,0x8cc001c062c01620,0xa0287089988720,0x8ce07a8072e00600,0x79602a70899c8700
.quad 0x8b101668001076f0,0x1540380089a088f0,0x8b300c28103066d0,0xb003a0089a488d0,0x8b5001e8205056b0,0xc0381089a888b0,0x8b707aa830704690,0x79803a1089ac8890
.quad 0x8b901660409074f0,0x1538382089b08870,0x8bb00c2050b064d0,0xaf83a2089b48850,0x8bd001e060d054b0,0xb8383089b88830,0x8bf07aa070f04490,0x79783a3089bc8810
.quad 0x8c10165802103470,0x1530384089c087f0,0x8c300c1812302450,0xaf03a4089c487d0,0x8c5001d822501430,0xb0385089c887b0,0x8c707a9832700410,0x79703a5089cc8790
.quad 0x8c90165042903670,0x1528386089d08770,0x8cb00c1052b02650,0xae83a6089d48750,0x8cd001d062d01630,0xa8387089d88730,0x8cf07a9072f00610,0x79683a7089dc8710
.quad 0x8b20167800207700,0x1548480089e088f8,0x8b400c38104066e0,0xb084a0089e488d8,0x8b6001f8206056c0,0xc8481089e888b8,0x8b807ab8308046a0,0x79884a1089ec8898
.quad 0x8ba0167040a07500,0x1540482089f08878,0x8bc00c3050c064e0,0xb004a2089f48858,0x8be001f060e054c0,0xc0483089f88838,0x8c007ab0710044a0,0x79804a3089fc8818
.quad 0x8c20166802203480,0x153848408a0087f8,0x8c400c2812402460,0xaf84a408a0487d8,0x8c6001e822601440,0xb848508a0887b8,0x8c807aa832800420,0x79784a508a0c8798
.quad 0x8ca0166042a03680,0x153048608a108778,0x8cc00c2052c02660,0xaf04a608a148758,0x8ce001e062e01640,0xb048708a188738,0x8d007aa073000620,0x79704a708a1c8718
.quad 0x8b30168800307710,0x155058008a2088e8,0x8b500c48105066f0,0xb105a008a2488c8,0x8b700208207056d0,0xd058108a2888a8,0x8b907ac8309046b0,0x79905a108a2c8888
.quad 0x8bb0168040b07510,0x154858208a308868,0x8bd00c4050d064f0,0xb085a208a348848,0x8bf0020060f054d0,0xc858308a388828,0x8c107ac0711044b0,0x79885a308a3c8808
.quad 0x8c30167802303490,0x154058408a4087e8,0x8c500c3812502470,0xb005a408a4487c8,0x8c7001f822701450,0xc058508a4887a8,0x8c907ab832900430,0x79805a508a4c8788
.quad 0x8cb0167042b03690,0x153858608a508768,0x8cd00c3052d02670,0xaf85a608a548748,0x8cf001f062f01650,0xb858708a588728,0x8d107ab073100630,0x79785a708a5c8708
.quad 0x8a8015d800000a00,0x15182c00104086e0,0x8aa00b98102078e0,0xad82e00104486c0,0x8ac00158204068c0,0x982c10104886a0,0x8ae07a18306068c0,0x79582e10104c8680
.quad 0x8b0015d040804880,0x15102c2010508660,0x8b200b9050a03860,0xad02e2010548640,0x8b40015060c02840,0x902c3010588620,0x8b607a1070e02840,0x79502e30105c8600
.quad 0x8b8015c802002840,0x15082c4089f885e0,0x8ba00b8812201820,0xac82e4089fc85c0,0x8bc0014822400800,0x882c508a0085a0,0x8be07a0832600800,0x79482e508a048580
.quad 0x8c0015c0428068c0,0x15002c608a088560,0x8c200b8052a058a0,0xac02e608a0c8540,0x8c40014062c04880,0x802c708a108520,0x8c607a0072e04880,0x79402e708a148500
.quad 0x8a9015e800100a10,0x15203c008a1886f0,0x8ab00ba8103078f0,0xae03e008a1c86d0,0x8ad00168205068d0,0xa03c108a2086b0,0x8af07a28307068d0,0x79603e108a248690
.quad 0x8b1015e040904890,0x15183c208a288670,0x8b300ba050b03870,0xad83e208a2c8650,0x8b50016060d02850,0x983c308a308630,0x8b707a2070f02850,0x79583e308a348610
.quad 0x8b9015d802102850,0x15103c408a3885f0,0x8bb00b9812301830,0xad03e408a3c85d0,0x8bd0015822500810,0x903c508a4085b0,0x8bf07a1832700810,0x79503e508a448590
.quad 0x8c1015d0429068d0,0x15083c608a488570,0x8c300b9052b058b0,0xac83e608a4c8550,0x8c50015062d04890,0x883c708a508530,0x8c707a1072f04890,0x79483e708a548510
.quad 0x8aa015f800200a20,0x15284c008a5886f8,0x8ac00bb810407900,0xae84e008a5c86d8,0x8ae00178206068e0,0xa84c108a6086b8,0x8b007a38308068e0,0x79684e108a648698
.quad 0x8b2015f040a048a0,0x15204c208a688678,0x8b400bb050c03880,0xae04e208a6c8658,0x8b60017060e02860,0xa04c308a708638,0x8b807a3071002860,0x79604e308a748618
.quad 0x8ba015e802202860,0x15184c408a7885f8,0x8bc00ba812401840,0xad84e408a7c85d8,0x8be0016822600820,0x984c508a8085b8,0x8c007a2832800820,0x79584e508a848598
.quad 0x8c2015e042a068e0,0x15104c608a888578,0x8c400ba052c058c0,0xad04e608a8c8558,0x8c60016062e048a0,0x904c708a908538,0x8c807a20730048a0,0x79504e708a948518
.quad 0x8ab0160800300a30,0x15305c008a9886e8,0x8ad00bc810507910,0xaf05e008a9c86c8,0x8af00188207068f0,0xb05c108aa086a8,0x8b107a48309068f0,0x79705e108aa48688
.quad 0x8b30160040b048b0,0x15285c208aa88668,0x8b500bc050d03890,0xae85e208aac8648,0x8b70018060f02870,0xa85c308ab08628,0x8b907a4071102870,0x79685e308ab48608
.quad 0x8bb015f802302870,0x15205c408ab885e8,0x8bd00bb812501850,0xae05e408abc85c8,0x8bf0017822700830,0xa05c508ac085a8,0x8c107a3832900830,0x79605e508ac48588
.quad 0x8c3015f042b068f0,0x15185c608ac88568,0x8c500bb052d058d0,0xad85e608acc8548,0x8c70017062f048b0,0x985c708ad08528,0x8c907a30731048b0,0x79585e708ad48508
.quad 0x8a00155800002c40,0x14f830001a8082e0,0x8a200b1810201c20,0xab832001a8482c0,0x8a4000d820400c00,0x7830101a8882a0,0x8a60799830600c00,0x793832101a8c8280
.quad 0x8a80155040805aa0,0x14f030201a908260,0x8aa00b1050a04a80,0xab032201a948240,0x8ac000d060c03a60,0x7030301a988220,0x8ae0799070e03a60,0x793032301a9c8200
.quad 0x8b00154802003a60,0x14e830408a7081e0,0x8b200b0812202a40,0xaa832408a7481c0,0x8b4000c822401a20,0x6830508a7881a0,0x8b60798832601a20,0x792832508a7c8180
.quad 0x8b80154042800c00,0x14e030608a808160,0x8ba00b0052a07ae0,0xaa032608a848140,0x8bc000c062c06ac0,0x6030708a888120,0x8be0798072e06ac0,0x792032708a8c8100
.quad 0x8a10156800102c50,0x150040008a9084e0,0x8a300b2810301c30,0xac042008a9484c0,0x8a5000e820500c10,0x8040108a9884a0,0x8a7079a830700c10,0x794042108a9c8480
.quad 0x8a90156040905ab0,0x14f840208aa08460,0x8ab00b2050b04a90,0xab842208aa48440,0x8ad000e060d03a70,0x7840308aa88420,0x8af079a070f03a70,0x793842308aac8400
.quad 0x8b10155802103a70,0x14f040408ab083e0,0x8b300b1812302a50,0xab042408ab483c0,0x8b5000d822501a30,0x7040508ab883a0,0x8b70799832701a30,0x793042508abc8380
.quad 0x8b90155042900c10,0x14e840608ac08360,0x8bb00b1052b07af0,0xaa842608ac48340,0x8bd000d062d06ad0,0x6840708ac88320,0x8bf0799072f06ad0,0x792842708acc8300
.quad 0x8a20157800202c60,0x150850008ad084f0,0x8a400b3810401c40,0xac852008ad484d0,0x8a6000f820600c20,0x8850108ad884b0,0x8a8079b830800c20,0x794852108adc8490
.quad 0x8aa0157040a05ac0,0x150050208ae08470,0x8ac00b3050c04aa0,0xac052208ae48450,0x8ae000f060e03a80,0x8050308ae88430,0x8b0079b071003a80,0x794052308aec8410
.quad 0x8b20156802203a80,0x14f850408af083f0,0x8b400b2812402a60,0xab852408af483d0,0x8b6000e822601a40,0x7850508af883b0,0x8b8079a832801a40,0x793852508afc8390
.quad 0x8ba0156042a00c20,0x14f050608b008370,0x8bc00b2052c07b00,0xab052608b048350,0x8be000e062e06ae0,0x7050708b088330,0x8c0079a073006ae0,0x793052708b0c8310
.quad 0x8a30158800302c70,0x151060008b1082f0,0x8a500b4810501c50,0xad062008b1482d0,0x8a70010820700c30,0x9060108b1882b0,0x8a9079c830900c30,0x795062108b1c8290
.quad 0x8ab0158040b05ad0,0x150860208b208270,0x8ad00b4050d04ab0,0xac862208b248250,0x8af0010060f03a90,0x8860308b288230,0x8b1079c071103a90,0x794862308b2c8210
.quad 0x8b30157802303a90,0x150060408b3081f0,0x8b500b3812502a70,0xac062408b3481d0,0x8b7000f822701a50,0x8060508b3881b0,0x8b9079b832901a50,0x794062508b3c8190
.quad 0x8bb0157042b00c30,0x14f860608b408170,0x8bd00b3052d07b10,0xab862608b448150,0x8bf000f062f06af0,0x7860708b488130,0x8c1079b073106af0,0x793862708b4c8110
.quad 0x898014d800002e40,0x14d8340024c07f9e,0x89a00a9810201e20,0xa98360024c47f9c,0x89c0005820401e20,0x58341024c87f9a,0x89e0791830601e20,0x7918361024cc7f98
.quad 0x8a0014d040806cc0,0x14d0342024d07f96,0x8a200a9050a05ca0,0xa90362024d47f94,0x8a40005060c05ca0,0x50343024d87f92,0x8a60791070e05ca0,0x7910363024dc7f90
.quad 0x8a8014c802004c80,0x14c834408ae87f8e,0x8aa00a8812203c60,0xa8836408aec7f8c,0x8ac0004822403c60,0x4834508af07f8a,0x8ae0790832603c60,0x790836508af47f88
.quad 0x8b0014c042800e00,0x14c034608af87f86,0x8b200a8052a07ce0,0xa8036608afc7f84,0x8b40004062c07ce0,0x4034708b007f82,0x8b60790072e07ce0,0x790036708b047f80
.quad 0x899014e800102e50,0x14e044008b087fde,0x89b00aa810301e30,0xaa046008b0c7fdc,0x89d0006820501e30,0x6044108b107fda,0x89f0792830701e30,0x792046108b147fd8
.quad 0x8a1014e040906cd0,0x14d844208b187fd6,0x8a300aa050b05cb0,0xa9846208b1c7fd4,0x8a50006060d05cb0,0x5844308b207fd2,0x8a70792070f05cb0,0x791846308b247fd0
.quad 0x8a9014d802104c90,0x14d044408b287fce,0x8ab00a9812303c70,0xa9046408b2c7fcc,0x8ad0005822503c70,0x5044508b307fca,0x8af0791832703c70,0x791046508b347fc8
.quad 0x8b1014d042900e10,0x14c844608b387fc6,0x8b300a9052b07cf0,0xa8846608b3c7fc4,0x8b50005062d07cf0,0x4844708b407fc2,0x8b70791072f07cf0,0x790846708b447fc0
.quad 0x89a014f800202e60,0x14e854008b487ffe,0x89c00ab810401e40,0xaa856008b4c7ffc,0x89e0007820601e40,0x6854108b507ffa,0x8a00793830801e40,0x792856108b547ff8
.quad 0x8a2014f040a06ce0,0x14e054208b587ff6,0x8a400ab050c05cc0,0xaa056208b5c7ff4,0x8a60007060e05cc0,0x6054308b607ff2,0x8a80793071005cc0,0x792056308b647ff0
.quad 0x8aa014e802204ca0,0x14d854408b687fee,0x8ac00aa812403c80,0xa9856408b6c7fec,0x8ae0006822603c80,0x5854508b707fea,0x8b00792832803c80,0x791856508b747fe8
.quad 0x8b2014e042a00e20,0x14d054608b787fe6,0x8b400aa052c07d00,0xa9056608b7c7fe4,0x8b60006062e07d00,0x5054708b807fe2,0x8b80792073007d00,0x791056708b847fe0
.quad 0x89b0150800302e70,0x14f064008b887fbe,0x89d00ac810501e50,0xab066008b8c7fbc,0x89f0008820701e50,0x7064108b907fba,0x8a10794830901e50,0x793066108b947fb8
.quad 0x8a30150040b06cf0,0x14e864208b987fb6,0x8a500ac050d05cd0,0xaa866208b9c7fb4,0x8a70008060f05cd0,0x6864308ba07fb2,0x8a90794071105cd0,0x792866308ba47fb0
.quad 0x8ab014f802304cb0,0x14e064408ba87fae,0x8ad00ab812503c90,0xaa066408bac7fac,0x8af0007822703c90,0x6064508bb07faa,0x8b10793832903c90,0x792066508bb47fa8
.quad 0x8b3014f042b00e30,0x14d864608bb87fa6,0x8b500ab052d07d10,0xa9866608bbc7fa4,0x8b70007062f07d10,0x5864708bc07fa2,0x8b90793073107d10,0x791866708bc47fa0
.quad 0x0,0x3f803f803f800000,0x0,0x3f803f8000000000,0x0,0x3f80000000000000,0x0,0x0
.quad 0x0,0x0,0x0,0x0,0x0,0x0,0x0,0x0
.quad 0x0,0x0,0x0,0x0,0x0,0x0,0x0,0x0
.quad 0x0,0x0,0x0,0x0,0x0,0x0,0x0,0x0
.quad 0x3f803f803f803f80,0x0,0x3f803f803f803f80,0x3f80,0x3f803f803f803f80,0x3f803f80,0x3f803f803f803f80,0x3f803f803f80
.quad 0x3f803f803f800000,0x3f803f803f803f80,0x3f803f8000000000,0x3f803f803f803f80,0x3f80000000000000,0x3f803f803f803f80,0x0,0x3f803f803f803f80
.quad 0x0,0x3f803f803f800000,0x0,0x3f803f8000000000,0x0,0x3f80000000000000,0x0,0x0
.quad 0x0,0x0,0x0,0x0,0x0,0x0,0x0,0x0
.quad 0x0,0x0,0x0,0x0,0x0,0x0,0x0,0x0
.quad 0x0,0x0,0x3f80,0x0,0x3f803f80,0x0,0x3f803f803f80,0x0
.quad 0x3f803f803f803f80,0x0,0x3f803f803f803f80,0x3f80,0x3f803f803f803f80,0x3f803f80,0x3f803f803f803f80,0x3f803f803f80
.quad 0x3f803f803f800000,0x3f803f803f803f80,0x3f803f8000000000,0x3f803f803f803f80,0x3f80000000000000,0x3f803f803f803f80,0x0,0x3f803f803f803f80
.quad 0x0,0x0,0x0,0x0,0x0,0x0,0x0,0x0
.quad 0x0,0x0,0x0,0x0,0x0,0x0,0x0,0x0
.quad 0x0,0x0,0x0,0x0,0x0,0x0,0x0,0x0
.quad 0x0,0x0,0x3f80,0x0,0x3f803f80,0x0,0x3f803f803f80,0x0
.quad 0x0,0x3f803f803f803f80,0x0,0x3f803f803f800000,0x0,0x3f803f8000000000,0x0,0x3f80000000000000
.quad 0x0,0x0,0x0,0x0,0x0,0x0,0x0,0x0
.quad 0x0,0x0,0x0,0x0,0x0,0x0,0x0,0x0
.quad 0x0,0x0,0x0,0x0,0x0,0x0,0x0,0x0
.quad 0x3f803f803f803f80,0x3f80,0x3f803f803f803f80,0x3f803f80,0x3f803f803f803f80,0x3f803f803f80,0x3f803f803f803f80,0x3f803f803f803f80
.quad 0x3f803f803f803f80,0x3f803f803f803f80,0x3f803f803f800000,0x3f803f803f803f80,0x3f803f8000000000,0x3f803f803f803f80,0x3f80000000000000,0x3f803f803f803f80
.quad 0x0,0x3f803f803f803f80,0x0,0x3f803f803f800000,0x0,0x3f803f8000000000,0x0,0x3f80000000000000
.quad 0x0,0x0,0x0,0x0,0x0,0x0,0x0,0x0
.quad 0x0,0x0,0x0,0x0,0x0,0x0,0x0,0x0
.quad 0x3f80,0x0,0x3f803f80,0x0,0x3f803f803f80,0x0,0x3f803f803f803f80,0x0
.quad 0x3f803f803f803f80,0x3f80,0x3f803f803f803f80,0x3f803f80,0x3f803f803f803f80,0x3f803f803f80,0x3f803f803f803f80,0x3f803f803f803f80
.quad 0x3f803f803f803f80,0x3f803f803f803f80,0x3f803f803f800000,0x3f803f803f803f80,0x3f803f8000000000,0x3f803f803f803f80,0x3f80000000000000,0x3f803f803f803f80
.quad 0x0,0x0,0x0,0x0,0x0,0x0,0x0,0x0
.quad 0x0,0x0,0x0,0x0,0x0,0x0,0x0,0x0
.quad 0x0,0x0,0x0,0x0,0x0,0x0,0x0,0x0
.quad 0x3f80,0x0,0x3f803f80,0x0,0x3f803f803f80,0x0,0x3f803f803f803f80,0x0
.quad 0x3f80,0x0,0x3f800000,0x0,0x3f8000000000,0x0,0x3f80000000000000,0x0
.quad 0x0,0x3f80,0x0,0x3f800000,0x0,0x3f8000000000,0x0,0x3f80000000000000
.quad 0x0,0x0,0x0,0x0,0x0,0x0,0x0,0x0
.quad 0x0,0x0,0x0,0x0,0x0,0x0,0x0,0x0
.quad 0x3f80,0x0,0x3f800000,0x0,0x3f8000000000,0x0,0x3f80000000000000,0x0
.quad 0x0,0x3f80,0x0,0x3f800000,0x0,0x3f8000000000,0x0,0x3f80000000000000
.quad 0x0,0x0,0x0,0x0,0x0,0x0,0x0,0x0
.quad 0x0,0x0,0x0,0x0,0x0,0x0,0x0,0x0
.quad 0x3f80,0x0,0x3f800000,0x0,0x3f8000000000,0x0,0x3f80000000000000,0x0
.quad 0x0,0x3f80,0x0,0x3f800000,0x0,0x3f8000000000,0x0,0x3f80000000000000
.quad 0x0,0x0,0x0,0x0,0x0,0x0,0x0,0x0
.quad 0x0,0x0,0x0,0x0,0x0,0x0,0x0,0x0
.quad 0x3f80,0x0,0x3f800000,0x0,0x3f8000000000,0x0,0x3f80000000000000,0x0
.quad 0x0,0x3f80,0x0,0x3f800000,0x0,0x3f8000000000,0x0,0x3f80000000000000
.quad 0x0,0x0,0x0,0x0,0x0,0x0,0x0,0x0
.quad 0x0,0x0,0x0,0x0,0x0,0x0,0x0,0x0
.quad 0x0,0x0,0x0,0x0,0x0,0x0,0x0,0x0
.quad 0x0,0x0,0x0,0x0,0x0,0x0,0x0,0x0
.quad 0x3f80,0x0,0x3f800000,0x0,0x3f8000000000,0x0,0x3f80000000000000,0x0
.quad 0x0,0x3f80,0x0,0x3f800000,0x0,0x3f8000000000,0x0,0x3f80000000000000
.quad 0x0,0x0,0x0,0x0,0x0,0x0,0x0,0x0
.quad 0x0,0x0,0x0,0x0,0x0,0x0,0x0,0x0
.quad 0x3f80,0x0,0x3f800000,0x0,0x3f8000000000,0x0,0x3f80000000000000,0x0
.quad 0x0,0x3f80,0x0,0x3f800000,0x0,0x3f8000000000,0x0,0x3f80000000000000
.quad 0x0,0x0,0x0,0x0,0x0,0x0,0x0,0x0
.quad 0x0,0x0,0x0,0x0,0x0,0x0,0x0,0x0
.quad 0x3f80,0x0,0x3f800000,0x0,0x3f8000000000,0x0,0x3f80000000000000,0x0
.quad 0x0,0x3f80,0x0,0x3f800000,0x0,0x3f8000000000,0x0,0x3f80000000000000
.quad 0x0,0x0,0x0,0x0,0x0,0x0,0x0,0x0
.quad 0x0,0x0,0x0,0x0,0x0,0x0,0x0,0x0
.quad 0x3f80,0x0,0x3f800000,0x0,0x3f8000000000,0x0,0x3f80000000000000,0x0
.quad 0x0,0x3f80,0x0,0x3f800000,0x0,0x3f8000000000,0x0,0x3f80000000000000
.quad 0x3f8000003f80,0x0,0x3f8080003f808000,0x10009000100410,0x3f353f3500003f80,0x20012000200820,0x3f35bf353f808000,0x3001b000300c30
.quad 0x3f80248d00003f80,0x8024000081040,0x248dbf803f808000,0x1802d000181450,0x3f35bf3500003f80,0x28036000281860,0xbf35bf353f808000,0x3803f000381c70
.quad 0x250dbf8000003f80,0x90040000402000,0xbf80a50d3f808000,0x80049000502410,0xbf35bf3500003f80,0xb0052000602820,0xbf353f353f808000,0xa005b000702c30
.quad 0xbf80a55400003f80,0x98064000483040,0xa5543f803f808000,0x8806d000583450,0xbf353f3500003f80,0xb8076000683860,0x3f353f353f808000,0xa807f000783c70
.quad 0x3f8000003f80,0x240100000800010,0x3f8080003f808000,0x250109000900400,0x3f35bf353f80248d,0x260112000a00830,0xbf35bf35248dbf80,0x27011b000b00c20
.quad 0xbf80a554250dbf80,0x248124000881050,0xa5543f80bf80a50d,0x25812d000981440,0x3f353f35bf80a554,0x268136000a81870,0x3f35bf35a5543f80,0x27813f000b81c60
.quad 0x250dbf8000003f80,0x2d0140000c02010,0xbf80a50d3f808000,0x2c0149000d02400,0xbf353f353f80248d,0x2f0152000e02830,0x3f353f35248dbf80,0x2e015b000f02c20
.quad 0x3f80248d250dbf80,0x2d8164000c83050,0x248dbf80bf80a50d,0x2c816d000d83440,0xbf35bf35bf80a554,0x2f8176000e83870,0xbf353f35a5543f80,0x2e817f000f83c60
.quad 0x3f8000003f80,0x400200001000020,0x3f8080003f808000,0x410209001100430,0xbf35bf35250dbf80,0x420212001200800,0xbf353f35bf80a50d,0x43021b001300c10
.quad 0x3f80248d00003f80,0x408224001081060,0x248dbf803f808000,0x41822d001181470,0xbf353f35250dbf80,0x428236001281840,0x3f353f35bf80a50d,0x43823f001381c50
.quad 0x250dbf8000003f80,0x490240001402020,0xbf80a50d3f808000,0x480249001502430,0x3f353f35250dbf80,0x4b0252001602800,0x3f35bf35bf80a50d,0x4a025b001702c10
.quad 0xbf80a55400003f80,0x498264001483060,0xa5543f803f808000,0x48826d001583470,0x3f35bf35250dbf80,0x4b8276001683840,0xbf35bf35bf80a50d,0x4a827f001783c50
.quad 0x3f8000003f80,0x640300001800030,0x3f8080003f808000,0x650309001900420,0xbf353f35bf80a554,0x660312001a00810,0x3f353f35a5543f80,0x67031b001b00c00
.quad 0xbf80a554250dbf80,0x648324001881070,0xa5543f80bf80a50d,0x65832d001981460,0xbf35bf353f80248d,0x668336001a81850,0xbf353f35248dbf80,0x67833f001b81c40
.quad 0x250dbf8000003f80,0x6d0340001c02030,0xbf80a50d3f808000,0x6c0349001d02420,0x3f35bf35bf80a554,0x6f0352001e02810,0xbf35bf35a5543f80,0x6e035b001f02c00
.quad 0x3f80248d250dbf80,0x6d8364001c83070,0x248dbf80bf80a50d,0x6c836d001d83460,0x3f353f353f80248d,0x6f8376001e83850,0x3f35bf35248dbf80,0x6e837f001f83c40
.quad 0xee00db015200000,0x4e504e50,0x36c035903d002820,0x30003046103550,0xf100df015600040,0x6000601e300d70,0x373035d03d402860,0x90009033f03510
.quad 0xf50201015a00080,0xc000c00bd00d30,0x377048303d8028a0,0xf000f033b034e0,0xf902050022000c0,0x12001200b900cc0,0x37b048702a0028e0,0x1500150337034a0
.quad 0xfd0209002600130,0x18001800b500c80,0x37f048b02a402910,0x1b001b033303460,0x223020d002a00170,0x1e001e00b100c40,0x4a1048f02a802950,0x210021032c03420
.quad 0x2270212002e001b0,0x24002404e504e50,0x4e504e504e504e50,0x27002704e504e50,0x4e504e504e504e50,0x2a002a04e504e50,0x4e504e504e504e50,0x2d002d04e504e50
.quad 0x2520100005b01670,0x800084e504e50,0x4d0038202d903e50,0x38003843a044f0,0x2560104005f016b0,0x6800681b801cd0,0x4d4038602dd03e90,0x980098436044b0
.quad 0x25a01080181016f0,0xc800c81b401c90,0x4d8038a040303ed0,0xf800f843204470,0x122010c018501700,0x12801281b001c50,0x3a0038e040703f20,0x158015842d04430
.quad 0x1260113018901740,0x18801881af01c10,0x3a40391040b03f60,0x1b801b8429031d0,0x12a0117018d01780,0x1e801e81ab009f0,0x3a80395040f03fa0,0x218021842503190
.quad 0x12e011b019200400,0x24802484e504e50,0x4e504e504e504e50,0x27802784e504e50,0x4e504e504e504e50,0x2a802a84e504e50,0x4e504e504e504e50,0x2d802d84e504e50
.quad 0x4e502670080006e0,0x48000104e504e50,0x4cf04e1030202ec0,0x4b000402d502e80,0x24d0263008400710,0x4e00070057006a0,0x4cb03bf030602f30,0x51000a02d102e40
.quad 0x249013d008800750,0x54000d005300660,0x4c703bb030a02f70,0x57001002ce02e00,0x2450139008c00790,0x5a0013004c00620,0x4c303b7030e02fb0,0x5d001602ca04180
.quad 0x24101350093007d0,0x6000190048019a0,0x39d03b3031102ff0,0x63001c02c604140,0x11f0131009701a30,0x66001f004401960,0x39903ac031504210,0x69002202c204100
.quad 0x4e504e5009b01a70,0x6c002504e504e50,0x4e504e504e504e50,0x6f002804e504e50,0x4e504e504e504e50,0x72002b04e504e50,0x4e504e504e504e50,0x75002e04e504e50
.quad 0x4e504e501e701d20,0x48800184e504e50,0x36804ba046504500,0x4b800483cf03e10,0xea023801eb01d60,0x4e8007814d01630,0x36404b6046904540,0x51800a83cb02bf0
.quad 0xe6023401ef01da0,0x54800d8149003d0,0x36004b2046d04580,0x57801083c702bb0,0xe2023001f000a20,0x5a8013814500390,0x49804ad047203200,0x5d801683c302b70
.quad 0x21a022f01f400a60,0x608019814100350,0x49404a9047603240,0x63801c829d02b30,0x216022b01f800aa0,0x66801f801f00310,0x49004a5047a03280,0x698022829902ac0
.quad 0x4e504e500c000ae0,0x6c802584e504e50,0x4e504e504e504e50,0x6f802884e504e50,0x4e504e504e504e50,0x72802b84e504e50,0x4e504e504e504e50,0x75802e84e504e50
.quad 0x3f8000003f80,0x3f8000003f80,0x3e853f7700003f80,0x3f35bf353f5ebf00,0x3f003f5e00003f80,0xbf80a554bf5ebf00,0x3f353f3500003f80,0x3f353f3500003f80
.quad 0x3f5e3f0000003f80,0x250dbf803f5ebf00,0x3f773e8500003f80,0xbf353f35bf5ebf00,0x3f80248d00003f80,0x3f80248d00003f80,0x3f77be8500003f80,0xbf35bf353f5ebf00
.quad 0x3f5ebf0000003f80,0x3f80bf5ebf00,0x3f35bf3500003f80,0x3f35bf3500003f80,0x3f00bf5e00003f80,0xbf80a5543f5ebf00,0x3e85bf7700003f80,0x3f353f35bf5ebf00
.quad 0x250dbf8000003f80,0x250dbf8000003f80,0xbe85bf7700003f80,0xbf353f353f5ebf00,0xbf00bf5e00003f80,0x3f80248dbf5ebf00,0xbf35bf3500003f80,0xbf35bf3500003f80
.quad 0x3f8000003f80,0x3f8000003f80,0x3f353f353f003f5e,0x3e85bf773f00bf5e,0x3f80248d3f5e3f00,0xbf003f5ebf5e3f00,0x3f35bf353f80248d,0x3f35bf353f80248d
.quad 0x250dbf803f5ebf00,0xbf5e3f00bf5ebf00,0xbf35bf353f00bf5e,0x3f77be853f003f5e,0xbf80a554250dbf80,0xbf80a554250dbf80,0xbf353f35bf00bf5e,0x3f773e85bf003f5e
.quad 0x3f80bf5ebf00,0xbf5ebf003f5ebf00,0x3f353f35bf80a554,0x3f353f35bf80a554,0x3f80248dbf5e3f00,0xbf00bf5e3f5e3f00,0x3f35bf35bf003f5e,0x3e853f77bf00bf5e
.quad 0x250dbf8000003f80,0x250dbf8000003f80,0xbf35bf353f003f5e,0xbe853f773f00bf5e,0xbf80a5543f5e3f00,0x3f00bf5ebf5e3f00,0xbf353f353f80248d,0xbf353f353f80248d
.quad 0x3f8000003f80,0x80003f8080003f80,0x3f773e853f5e3f00,0x3e85bf77a50dbf80,0x3f00bf5e3f5ebf00,0xbf003f5e80003f80,0xbf35bf35250dbf80,0x3f35bf35a50dbf80
.quad 0xbf5e3f00bf5ebf00,0xbf5e3f0080003f80,0x3e853f77bf5e3f00,0x3f77be85a50dbf80,0x3f80248d00003f80,0xbf80248d80003f80,0x3e85bf773f5e3f00,0x3f773e85a50dbf80
.quad 0xbf5ebf003f5ebf00,0xbf5ebf0080003f80,0xbf353f35250dbf80,0x3f353f35a50dbf80,0x3f003f5ebf5ebf00,0xbf00bf5e80003f80,0x3f77be85bf5e3f00,0x3e853f77a50dbf80
.quad 0x250dbf8000003f80,0xa50dbf8080003f80,0xbf77be853f5e3f00,0xbe853f77a50dbf80,0xbf003f5e3f5ebf00,0x3f00bf5e80003f80,0x3f353f35250dbf80,0xbf353f35a50dbf80
.quad 0x3f8000003f80,0x80003f8080003f80,0x3f77be853f80248d,0x3f35bf353f00bf5e,0xbf00bf5e250dbf80,0xbf80248dbf5e3f00,0xbf353f35bf80a554,0x3f353f353f80a554
.quad 0x3f5e3f0000003f80,0xa50dbf80bf5ebf00,0x3e85bf773f80248d,0xbf353f353f003f5e,0xbf80a554250dbf80,0x3f80a554a50dbf80,0x3e853f77bf80a554,0xbf35bf35bf003f5e
.quad 0x3f5ebf0000003f80,0x80003f803f5ebf00,0xbf35bf353f80248d,0x3f35bf35bf80248d,0xbf003f5e250dbf80,0xbf80248d3f5e3f00,0x3f773e85bf80a554,0x3f353f35bf00bf5e
.quad 0x250dbf8000003f80,0xa50dbf8080003f80,0xbf773e853f80248d,0xbf353f353f00bf5e,0x3f003f5e250dbf80,0x3f80a554bf5e3f00,0x3f35bf35bf80a554,0xbf35bf353f80a554
.quad 0x3f8080003f808000,0x3f8080003f808000,0x3f77be853f808000,0xbf35bf35bf00bf5e,0x3f5ebf003f808000,0xa5543f80bf003f5e,0x3f35bf353f808000,0x3f35bf353f808000
.quad 0x3f00bf5e3f808000,0xbf80a50dbf00bf5e,0x3e85bf773f808000,0x3f353f35bf003f5e,0x248dbf803f808000,0x248dbf803f808000,0xbe85bf773f808000,0xbf353f35bf00bf5e
.quad 0xbf00bf5e3f808000,0x3f808000bf003f5e,0xbf35bf353f808000,0xbf35bf353f808000,0xbf5ebf003f808000,0xa5543f80bf00bf5e,0xbf77be853f808000,0x3f35bf35bf003f5e
.quad 0xbf80a50d3f808000,0xbf80a50d3f808000,0xbf773e853f808000,0x3f353f35bf00bf5e,0xbf5e3f003f808000,0x248dbf80bf003f5e,0xbf353f353f808000,0xbf353f353f808000
.quad 0x3f8080003f808000,0x3f8080003f808000,0x3f35bf353f5ebf00,0xbf77be85bf5ebf00,0x248dbf803f00bf5e,0x3f5e3f003f003f5e,0xbf35bf35248dbf80,0xbf35bf35248dbf80
.quad 0xbf80a50dbf00bf5e,0x3f003f5ebf003f5e,0xbf353f35bf5ebf00,0xbe85bf773f5ebf00,0xa5543f80bf80a50d,0xa5543f80bf80a50d,0x3f353f35bf5e3f00,0x3e85bf773f5e3f00
.quad 0x3f808000bf003f5e,0xbf003f5ebf00bf5e,0x3f35bf35a5543f80,0x3f35bf35a5543f80,0x248dbf803f003f5e,0xbf5e3f003f00bf5e,0xbf35bf353f5e3f00,0x3f77be85bf5e3f00
.quad 0xbf80a50d3f808000,0xbf80a50d3f808000,0xbf353f353f5ebf00,0x3f773e85bf5ebf00,0xa5543f803f00bf5e,0xbf5ebf003f003f5e,0x3f353f35248dbf80,0x3f353f35248dbf80
.quad 0x3f8080003f808000,0xbf808000bf808000,0x3e85bf773f00bf5e,0x3f773e853f80a50d,0xbf5ebf00bf00bf5e,0xbf5ebf00bf808000,0xbf353f35bf80a50d,0x3f353f353f80a50d
.quad 0x3f003f5ebf003f5e,0xbf00bf5ebf808000,0x3f77be853f003f5e,0x3e853f773f80a50d,0x248dbf803f808000,0xa48dbf80bf808000,0xbf77be853f00bf5e,0xbe853f773f80a50d
.quad 0xbf003f5ebf00bf5e,0x3f00bf5ebf808000,0x3f353f35bf80a50d,0xbf353f353f80a50d,0x3f5ebf00bf003f5e,0x3f5ebf00bf808000,0xbe85bf773f003f5e,0xbf773e853f80a50d
.quad 0xbf80a50d3f808000,0x3f80a50dbf808000,0xbe853f773f00bf5e,0xbf77be853f80a50d,0x3f5e3f00bf00bf5e,0x3f5e3f00bf808000,0x3f35bf35bf80a50d,0xbf35bf353f80a50d
.quad 0x3f8080003f808000,0xbf808000bf808000,0xbe85bf77248dbf80,0x3f353f353f5e3f00,0xbf5e3f00bf80a50d,0xa48dbf80bf00bf5e,0x3f353f35a5543f80,0xbf353f3525543f80
.quad 0x3f00bf5e3f808000,0x3f80a50d3f00bf5e,0xbf77be85248dbf80,0xbf35bf35bf5e3f00,0xa5543f80bf80a50d,0x25543f803f80a50d,0x3f77be85a5543f80,0x3f35bf35bf5ebf00
.quad 0xbf00bf5e3f808000,0xbf8080003f003f5e,0xbf353f35248dbf80,0x3f353f35a48dbf80,0x3f5e3f00bf80a50d,0xa48dbf80bf003f5e,0x3e85bf77a5543f80,0xbf353f353f5ebf00
.quad 0xbf80a50d3f808000,0x3f80a50dbf808000,0x3e853f77248dbf80,0xbf35bf353f5e3f00,0x3f5ebf00bf80a50d,0x25543f80bf00bf5e,0xbf35bf35a5543f80,0x3f35bf3525543f80
.quad 0x80003f8080003f80,0xbf808000bf808000,0x3f77be853f5ebf00,0x3e853f773f003f5e,0xbf00bf5ebf5ebf00,0x3f5ebf003f00bf5e,0xbf353f3580003f80,0xbf35bf35bf808000
.quad 0x3f5e3f003f5ebf00,0xbf003f5e3f003f5e,0x3e85bf77bf5ebf00,0x3f773e853f00bf5e,0xbf80248d80003f80,0xa48dbf80bf808000,0x3e853f773f5ebf00,0xbf773e853f003f5e
.quad 0x3f5ebf00bf5ebf00,0x3f003f5e3f00bf5e,0xbf35bf3580003f80,0x3f35bf35bf808000,0xbf003f5e3f5ebf00,0xbf5ebf003f003f5e,0x3f773e85bf5ebf00,0xbe853f773f00bf5e
.quad 0xa50dbf8080003f80,0x3f80a50dbf808000,0xbf773e853f5ebf00,0xbe85bf773f003f5e,0x3f003f5ebf5ebf00,0xbf5e3f003f00bf5e,0x3f35bf3580003f80,0x3f353f35bf808000
.quad 0x80003f8080003f80,0xbf808000bf808000,0x3f773e853f80a554,0xbe853f7725543f80,0x3f00bf5ea50dbf80,0x3f5e3f003f80a50d,0xbf35bf35bf80248d,0x3f35bf35a48dbf80
.quad 0xbf5e3f0080003f80,0xbf00bf5ebf808000,0x3e853f773f80a554,0xbf773e8525543f80,0x3f80a554a50dbf80,0x25543f803f80a50d,0x3e85bf77bf80248d,0x3f773e85a48dbf80
.quad 0xbf5ebf0080003f80,0x3f00bf5ebf808000,0xbf353f353f80a554,0xbf35bf3525543f80,0x3f003f5ea50dbf80,0xbf5e3f003f80a50d,0x3f77be85bf80248d,0x3e853f77a48dbf80
.quad 0xa50dbf8080003f80,0x3f80a50dbf808000,0xbf77be853f80a554,0x3e85bf7725543f80,0xbf003f5ea50dbf80,0xbf5ebf003f80a50d,0x3f353f35bf80248d,0xbf353f35a48dbf80
.quad 0x80003f8080003f80,0xbf808000bf808000,0x3f353f353f5e3f00,0xbf353f35bf003f5e,0x3f80a5543f5ebf00,0x25543f803f003f5e,0x3f35bf35a50dbf80,0x3f353f353f80a50d
.quad 0xa50dbf80bf5ebf00,0x3f80a50d3f00bf5e,0xbf35bf35bf5e3f00,0x3f35bf35bf00bf5e,0xbf80248d80003f80,0xa48dbf80bf808000,0xbf353f353f5e3f00,0xbf35bf35bf003f5e
.quad 0x80003f803f5ebf00,0xbf8080003f003f5e,0x3f353f35a50dbf80,0xbf353f353f80a50d,0x3f80a554bf5ebf00,0x25543f803f00bf5e,0x3f35bf35bf5e3f00,0x3f353f35bf00bf5e
.quad 0xa50dbf8080003f80,0x3f80a50dbf808000,0xbf35bf353f5e3f00,0x3f35bf35bf003f5e,0xbf80248d3f5ebf00,0xa48dbf803f003f5e,0xbf353f35a50dbf80,0xbf35bf353f80a50d
.quad 0x80003f8080003f80,0xbf808000bf808000,0x3e853f773f003f5e,0xbf773e85bf5e3f00,0x3f003f5e3f5e3f00,0xbf5e3f00bf003f5e,0x3f353f353f80a554,0xbf353f3525543f80
.quad 0x3f5e3f003f5ebf00,0xbf003f5e3f003f5e,0x3f773e853f00bf5e,0xbe853f773f5e3f00,0x3f80a554a50dbf80,0x25543f803f80a50d,0x3f77be85bf00bf5e,0x3e853f773f5ebf00
.quad 0x3f5ebf00bf5ebf00,0x3f003f5e3f00bf5e,0x3f35bf35bf80248d,0x3f353f35a48dbf80,0x3f00bf5ebf5e3f00,0x3f5e3f00bf00bf5e,0x3e85bf77bf003f5e,0x3f773e85bf5ebf00
.quad 0xa50dbf8080003f80,0x3f80a50dbf808000,0xbe85bf773f003f5e,0x3f77be85bf5e3f00,0xbf00bf5e3f5e3f00,0x3f5ebf00bf003f5e,0xbf35bf353f80a554,0x3f35bf3525543f80
.quad 0xbf5ebf0000003f80,0x3f803f5ebf00,0xbf77be8500003f80,0x3f35bf35bf5ebf00,0xbf80a55400003f80,0xbf80a55400003f80,0xbf773e8500003f80,0x3f353f353f5ebf00
.quad 0xbf5e3f0000003f80,0x250dbf80bf5ebf00,0xbf353f3500003f80,0xbf353f3500003f80,0xbf003f5e00003f80,0x3f80248d3f5ebf00,0xbe853f7700003f80,0xbf35bf35bf5ebf00
.quad 0x0,0x0,0x0,0x0,0x0,0x0,0x0,0x0
.quad 0x0,0x0,0x0,0x0,0x0,0x0,0x0,0x0
.quad 0x3f803f5ebf00,0x3f5ebf00bf5ebf00,0x3f353f353f00bf5e,0xbf773e853f003f5e,0x3f80248d250dbf80,0x3f80248d250dbf80,0x3f35bf35bf00bf5e,0xbf77be85bf003f5e
.quad 0x250dbf80bf5ebf00,0x3f5e3f003f5ebf00,0xbf35bf35bf80a554,0xbf35bf35bf80a554,0xbf80a554bf5e3f00,0x3f003f5e3f5e3f00,0xbf353f35bf003f5e,0xbe85bf77bf00bf5e
.quad 0x0,0x0,0x0,0x0,0x0,0x0,0x0,0x0
.quad 0x0,0x0,0x0,0x0,0x0,0x0,0x0,0x0
.quad 0x3f5ebf00bf5ebf00,0x3f5ebf0080003f80,0xbe85bf77bf5e3f00,0xbf773e85a50dbf80,0xbf80a55400003f80,0x3f80a55480003f80,0xbe853f773f5e3f00,0xbf77be85a50dbf80
.quad 0x3f5e3f003f5ebf00,0x3f5e3f0080003f80,0x3f35bf35250dbf80,0xbf35bf35a50dbf80,0xbf00bf5ebf5ebf00,0x3f003f5e80003f80,0xbf773e85bf5e3f00,0xbe85bf77a50dbf80
.quad 0x0,0x0,0x0,0x0,0x0,0x0,0x0,0x0
.quad 0x0,0x0,0x0,0x0,0x0,0x0,0x0,0x0
.quad 0xbf5ebf0000003f80,0x80003f80bf5ebf00,0xbe853f773f80248d,0x3f35bf353f003f5e,0x3f80248d250dbf80,0xbf80248da50dbf80,0xbe85bf77bf80a554,0x3f353f35bf003f5e
.quad 0xbf5e3f0000003f80,0xa50dbf803f5ebf00,0x3f353f353f80248d,0xbf353f35bf80248d,0x3f00bf5e250dbf80,0x3f80a5543f5e3f00,0xbf77be85bf80a554,0xbf35bf35bf00bf5e
.quad 0x0,0x0,0x0,0x0,0x0,0x0,0x0,0x0
.quad 0x0,0x0,0x0,0x0,0x0,0x0,0x0,0x0
.quad 0xbf003f5e3f808000,0x3f808000bf00bf5e,0xbe853f773f808000,0xbf35bf35bf003f5e,0xa5543f803f808000,0xa5543f803f808000,0x3e853f773f808000,0x3f35bf35bf00bf5e
.quad 0x3f003f5e3f808000,0xbf80a50dbf003f5e,0x3f353f353f808000,0x3f353f353f808000,0x3f5e3f003f808000,0x248dbf80bf00bf5e,0x3f773e853f808000,0xbf353f35bf003f5e
.quad 0x0,0x0,0x0,0x0,0x0,0x0,0x0,0x0
.quad 0x0,0x0,0x0,0x0,0x0,0x0,0x0,0x0
.quad 0x3f808000bf00bf5e,0xbf00bf5ebf003f5e,0x3f35bf35bf5ebf00,0x3e853f773f5ebf00,0x248dbf80bf80a50d,0x248dbf80bf80a50d,0xbf35bf35bf5e3f00,0xbe853f773f5e3f00
.quad 0xbf80a50dbf003f5e,0x3f00bf5ebf00bf5e,0xbf353f35a5543f80,0xbf353f35a5543f80,0xa5543f803f003f5e,0x3f5ebf003f00bf5e,0x3f353f353f5e3f00,0xbf773e85bf5e3f00
.quad 0x0,0x0,0x0,0x0,0x0,0x0,0x0,0x0
.quad 0x0,0x0,0x0,0x0,0x0,0x0,0x0,0x0
.quad 0xbf00bf5ebf003f5e,0x3f003f5ebf808000,0xbf773e853f003f5e,0xbe85bf773f80a50d,0xa5543f803f808000,0x25543f80bf808000,0x3f773e853f00bf5e,0x3e85bf773f80a50d
.quad 0x3f00bf5ebf00bf5e,0xbf003f5ebf808000,0xbf35bf35bf80a50d,0x3f35bf353f80a50d,0xbf5e3f00bf003f5e,0xbf5e3f00bf808000,0x3e853f773f003f5e,0x3f77be853f80a50d
.quad 0x0,0x0,0x0,0x0,0x0,0x0,0x0,0x0
.quad 0x0,0x0,0x0,0x0,0x0,0x0,0x0,0x0
.quad 0xbf003f5e3f808000,0xbf8080003f00bf5e,0x3f773e85248dbf80,0x3f353f35bf5e3f00,0x248dbf80bf80a50d,0xa48dbf803f80a50d,0xbf773e85a5543f80,0xbf353f35bf5ebf00
.quad 0x3f003f5e3f808000,0x3f80a50d3f003f5e,0x3f35bf35248dbf80,0xbf35bf35a48dbf80,0xbf5ebf00bf80a50d,0x25543f80bf003f5e,0xbe853f77a5543f80,0x3f35bf353f5ebf00
.quad 0x0,0x0,0x0,0x0,0x0,0x0,0x0,0x0
.quad 0x0,0x0,0x0,0x0,0x0,0x0,0x0,0x0
.quad 0xbf5ebf003f5ebf00,0x0,0xbe853f77bf5ebf00,0x0,0x3f80a55480003f80,0x0,0xbe85bf773f5ebf00,0x0
.quad 0xbf5e3f00bf5ebf00,0x0,0x3f353f3580003f80,0x0,0x3f00bf5e3f5ebf00,0x0,0xbf77be85bf5ebf00,0x0
.quad 0x0,0xbf5ebf003f5ebf00,0x0,0xbe853f77bf5ebf00,0x0,0x3f80a55480003f80,0x0,0xbe85bf773f5ebf00
.quad 0x0,0xbf5e3f00bf5ebf00,0x0,0x3f353f3580003f80,0x0,0x3f00bf5e3f5ebf00,0x0,0xbf77be85bf5ebf00
.quad 0x3f5ebf0080003f80,0x0,0xbe85bf773f80a554,0x0,0xbf80248da50dbf80,0x0,0xbe853f77bf80248d,0x0
.quad 0x3f5e3f0080003f80,0x0,0x3f35bf353f80a554,0x0,0xbf00bf5ea50dbf80,0x0,0xbf773e85bf80248d,0x0
.quad 0x0,0x3f5ebf0080003f80,0x0,0xbe85bf773f80a554,0x0,0xbf80248da50dbf80,0x0,0xbe853f77bf80248d
.quad 0x0,0x3f5e3f0080003f80,0x0,0x3f35bf353f80a554,0x0,0xbf00bf5ea50dbf80,0x0,0xbf773e85bf80248d
.quad 0x80003f80bf5ebf00,0x0,0x3f353f35bf5e3f00,0x0,0x3f80a55480003f80,0x0,0x3f35bf353f5e3f00,0x0
.quad 0xa50dbf803f5ebf00,0x0,0xbf35bf35a50dbf80,0x0,0xbf80248dbf5ebf00,0x0,0xbf353f35bf5e3f00,0x0
.quad 0x0,0x80003f80bf5ebf00,0x0,0x3f353f35bf5e3f00,0x0,0x3f80a55480003f80,0x0,0x3f35bf353f5e3f00
.quad 0x0,0xa50dbf803f5ebf00,0x0,0xbf35bf35a50dbf80,0x0,0xbf80248dbf5ebf00,0x0,0xbf353f35bf5e3f00
.quad 0xbf5ebf003f5ebf00,0x0,0xbf77be853f00bf5e,0x0,0xbf80248da50dbf80,0x0,0xbf773e85bf00bf5e,0x0
.quad 0xbf5e3f00bf5ebf00,0x0,0xbf353f35bf80248d,0x0,0xbf003f5ebf5e3f00,0x0,0xbe853f77bf003f5e,0x0
.quad 0x0,0xbf5ebf003f5ebf00,0x0,0xbf77be853f00bf5e,0x0,0xbf80248da50dbf80,0x0,0xbf773e85bf00bf5e
.quad 0x0,0xbf5e3f00bf5ebf00,0x0,0xbf353f35bf80248d,0x0,0xbf003f5ebf5e3f00,0x0,0xbe853f77bf003f5e
.quad 0x0,0x0,0x0,0x0,0x0,0x0,0x0,0x0
.quad 0x0,0x0,0x0,0x0,0x0,0x0,0x0,0x0
.quad 0xbf5ebf0000003f80,0x3f803f5ebf00,0xbf77be8500003f80,0x3f35bf35bf5ebf00,0xbf80a55400003f80,0xbf80a55400003f80,0xbf773e8500003f80,0x3f353f353f5ebf00
.quad 0xbf5e3f0000003f80,0x250dbf80bf5ebf00,0xbf353f3500003f80,0xbf353f3500003f80,0xbf003f5e00003f80,0x3f80248d3f5ebf00,0xbe853f7700003f80,0xbf35bf35bf5ebf00
.quad 0x0,0x0,0x0,0x0,0x0,0x0,0x0,0x0
.quad 0x0,0x0,0x0,0x0,0x0,0x0,0x0,0x0
.quad 0x3f803f5ebf00,0x3f5ebf00bf5ebf00,0x3f353f353f00bf5e,0xbf773e853f003f5e,0x3f80248d250dbf80,0x3f80248d250dbf80,0x3f35bf35bf00bf5e,0xbf77be85bf003f5e
.quad 0x250dbf80bf5ebf00,0x3f5e3f003f5ebf00,0xbf35bf35bf80a554,0xbf35bf35bf80a554,0xbf80a554bf5e3f00,0x3f003f5e3f5e3f00,0xbf353f35bf003f5e,0xbe85bf77bf00bf5e
.quad 0x0,0x0,0x0,0x0,0x0,0x0,0x0,0x0
.quad 0x0,0x0,0x0,0x0,0x0,0x0,0x0,0x0
.quad 0x3f5ebf00bf5ebf00,0x3f5ebf0080003f80,0xbe85bf77bf5e3f00,0xbf773e85a50dbf80,0xbf80a55400003f80,0x3f80a55480003f80,0xbe853f773f5e3f00,0xbf77be85a50dbf80
.quad 0x3f5e3f003f5ebf00,0x3f5e3f0080003f80,0x3f35bf35250dbf80,0xbf35bf35a50dbf80,0xbf00bf5ebf5ebf00,0x3f003f5e80003f80,0xbf773e85bf5e3f00,0xbe85bf77a50dbf80
.quad 0x0,0x0,0x0,0x0,0x0,0x0,0x0,0x0
.quad 0x0,0x0,0x0,0x0,0x0,0x0,0x0,0x0
.quad 0xbf5ebf0000003f80,0x80003f80bf5ebf00,0xbe853f773f80248d,0x3f35bf353f003f5e,0x3f80248d250dbf80,0xbf80248da50dbf80,0xbe85bf77bf80a554,0x3f353f35bf003f5e
.quad 0xbf5e3f0000003f80,0xa50dbf803f5ebf00,0x3f353f353f80248d,0xbf353f35bf80248d,0x3f00bf5e250dbf80,0x3f80a5543f5e3f00,0xbf77be85bf80a554,0xbf35bf35bf00bf5e
.quad 0x0,0x0,0x0,0x0,0x0,0x0,0x0,0x0
.quad 0x0,0x0,0x0,0x0,0x0,0x0,0x0,0x0
.quad 0xbf003f5e3f808000,0x3f808000bf00bf5e,0xbe853f773f808000,0xbf35bf35bf003f5e,0xa5543f803f808000,0xa5543f803f808000,0x3e853f773f808000,0x3f35bf35bf00bf5e
.quad 0x3f003f5e3f808000,0xbf80a50dbf003f5e,0x3f353f353f808000,0x3f353f353f808000,0x3f5e3f003f808000,0x248dbf80bf00bf5e,0x3f773e853f808000,0xbf353f35bf003f5e
.quad 0x0,0x0,0x0,0x0,0x0,0x0,0x0,0x0
.quad 0x0,0x0,0x0,0x0,0x0,0x0,0x0,0x0
.quad 0x3f808000bf00bf5e,0xbf00bf5ebf003f5e,0x3f35bf35bf5ebf00,0x3e853f773f5ebf00,0x248dbf80bf80a50d,0x248dbf80bf80a50d,0xbf35bf35bf5e3f00,0xbe853f773f5e3f00
.quad 0xbf80a50dbf003f5e,0x3f00bf5ebf00bf5e,0xbf353f35a5543f80,0xbf353f35a5543f80,0xa5543f803f003f5e,0x3f5ebf003f00bf5e,0x3f353f353f5e3f00,0xbf773e85bf5e3f00
.quad 0x0,0x0,0x0,0x0,0x0,0x0,0x0,0x0
.quad 0x0,0x0,0x0,0x0,0x0,0x0,0x0,0x0
.quad 0xbf00bf5ebf003f5e,0x3f003f5ebf808000,0xbf773e853f003f5e,0xbe85bf773f80a50d,0xa5543f803f808000,0x25543f80bf808000,0x3f773e853f00bf5e,0x3e85bf773f80a50d
.quad 0x3f00bf5ebf00bf5e,0xbf003f5ebf808000,0xbf35bf35bf80a50d,0x3f35bf353f80a50d,0xbf5e3f00bf003f5e,0xbf5e3f00bf808000,0x3e853f773f003f5e,0x3f77be853f80a50d
.quad 0x0,0x0,0x0,0x0,0x0,0x0,0x0,0x0
.quad 0x0,0x0,0x0,0x0,0x0,0x0,0x0,0x0
.quad 0xbf003f5e3f808000,0xbf8080003f00bf5e,0x3f773e85248dbf80,0x3f353f35bf5e3f00,0x248dbf80bf80a50d,0xa48dbf803f80a50d,0xbf773e85a5543f80,0xbf353f35bf5ebf00
.quad 0x3f003f5e3f808000,0x3f80a50d3f003f5e,0x3f35bf35248dbf80,0xbf35bf35a48dbf80,0xbf5ebf00bf80a50d,0x25543f80bf003f5e,0xbe853f77a5543f80,0x3f35bf353f5ebf00
.quad 0x3f00bf5e3f003f5e,0x0,0xbf77be853f00bf5e,0x0,0x25543f80bf808000,0x0,0x3f77be853f003f5e,0x0
.quad 0xbf00bf5e3f00bf5e,0x0,0xbf353f35bf808000,0x0,0x3f5e3f003f003f5e,0x0,0x3e85bf773f00bf5e,0x0
.quad 0x0,0x3f00bf5e3f003f5e,0x0,0xbf77be853f00bf5e,0x0,0x25543f80bf808000,0x0,0x3f77be853f003f5e
.quad 0x0,0xbf00bf5e3f00bf5e,0x0,0xbf353f35bf808000,0x0,0x3f5e3f003f003f5e,0x0,0x3e85bf773f00bf5e
.quad 0x3f003f5ebf808000,0x0,0x3f77be8525543f80,0x0,0xa48dbf803f80a50d,0x0,0xbf77be85a48dbf80,0x0
.quad 0xbf003f5ebf808000,0x0,0x3f353f3525543f80,0x0,0x3f5ebf003f80a50d,0x0,0xbe85bf77a48dbf80,0x0
.quad 0x0,0x3f003f5ebf808000,0x0,0x3f77be8525543f80,0x0,0xa48dbf803f80a50d,0x0,0xbf77be85a48dbf80
.quad 0x0,0xbf003f5ebf808000,0x0,0x3f353f3525543f80,0x0,0x3f5ebf003f80a50d,0x0,0xbe85bf77a48dbf80
.quad 0xbf8080003f00bf5e,0x0,0xbf353f35bf00bf5e,0x0,0x25543f80bf808000,0x0,0x3f353f35bf003f5e,0x0
.quad 0x3f80a50d3f003f5e,0x0,0x3f35bf353f80a50d,0x0,0xa48dbf803f00bf5e,0x0,0xbf35bf35bf00bf5e,0x0
.quad 0x0,0xbf8080003f00bf5e,0x0,0xbf353f35bf00bf5e,0x0,0x25543f80bf808000,0x0,0x3f353f35bf003f5e
.quad 0x0,0x3f80a50d3f003f5e,0x0,0x3f35bf353f80a50d,0x0,0xa48dbf803f00bf5e,0x0,0xbf35bf35bf00bf5e
.quad 0x3f00bf5e3f003f5e,0x0,0x3e85bf773f5e3f00,0x0,0xa48dbf803f80a50d,0x0,0xbe85bf773f5ebf00,0x0
.quad 0xbf00bf5e3f00bf5e,0x0,0xbf35bf35a48dbf80,0x0,0xbf5ebf00bf00bf5e,0x0,0xbf77be85bf5ebf00,0x0
.quad 0x0,0x3f00bf5e3f003f5e,0x0,0x3e85bf773f5e3f00,0x0,0xa48dbf803f80a50d,0x0,0xbe85bf773f5ebf00
.quad 0x0,0xbf00bf5e3f00bf5e,0x0,0xbf35bf35a48dbf80,0x0,0xbf5ebf00bf00bf5e,0x0,0xbf77be85bf5ebf00
.quad 0x35e38e3935e38e39,0x35e38e3935e38e39,0x35e38ac235e38e39,0x35e36f0835e3805c,0x35e3805c35e38e39,0x35e3117f35e356c7,0x35e36f0835e38e39,0x35e275b635e3117f
.quad 0x35e356c735e38e39,0x35e19bd935e2b08c,0x35e3379935e38e39,0x35e0842435e233fb,0x35e3117f35e38e39,0x35df2ee235e19bd9,0x35e2e47a35e38e39,0x35dd9c7235e0e83b
.quad 0x35e2b08c35e38e39,0x35dbcd4235e01936,0x35e275b635e38e39,0x35d9c1d135df2ee2,0x35e233fb35e38e39,0x35d77aae35de295d,0x35e1eb5b35e38e39,0x35d4f87935dd08c7
.quad 0x35e19bd935e38e39,0x35d23be235dbcd42,0x35e1457935e38e39,0x35cf45aa35da76f5,0x35e0e83b35e38e39,0x35cc16a035d9060a,0x35e0842435e38e39,0x35c8afa335d77aae
.quad 0x35e38e3935e38e39,0x35e38e3935e38e39,0x35e3379935e356c7,0x35e2e47a35e3117f,0x35e233fb35e2b08c,0x35e0e83b35e19bd9,0x35e0842435e19bd9,0x35dd9c7235df2ee2
.quad 0x35de295d35e01936,0x35d9060a35dbcd42,0x35db257235de295d,0x35d32bdb35d77aae,0x35d77aae35dbcd42,0x35cc16a035d23be2,0x35d32bdb35d9060a,0x35c3d0ea35cc16a0
.quad 0x35ce3c4135d5d510,0x35ba671135c511a3,0x35c8afa335d23be2,0x35afe71f35bd349e,0x35c28a3a35ce3c41,0x35a460c035b4882f,0x35bbd0b335c9d820,0x3597e52535ab15d8
.quad 0x35b4882f35c511a3,0x358a86ec35a0e7f5,0x35acb63735bfeb1d,0x3578b412359609ad,0x35a460c035ba6711,0x355ae741358a86ec,0x359b8e2335b4882f,0x353bd3db357cd8a0
.quad 0x35e38e3935e38e39,0x35e38e3935e38e39,0x35e275b635e2b08c,0x35e1eb5b35e233fb,0x35df2ee235e01936,0x35dd08c735de295d,0x35d9c1d135dbcd42,0x35d4f87935d77aae
.quad 0x35d23be235d5d510,0x35c9d82035ce3c41,0x35c8afa335ce3c41,0x35bbd0b335c28a3a,0x35bd349e35c511a3,0x35ab15d835b4882f,0x35afe71f35ba6711,0x3597e52535a460c0
.quad 0x35a0e7f535ae5153,0x3582854035924518,0x35905c1635a0e7f5,0x355689b3357cd8a0,0x357cd8a035924518,0x3524f3183552259d,0x355689b335828540,0x34e1fa763524f318
.quad 0x352e29da35638e39,0x346d9d9d34eb9535,0x35041c9e35405699,0x329edc50348a7751,0x34b19357351ba83c,0xb4462fa4339ed037,0x34326f4c34eb9535,0xb4ceb09bb3ee2023
.quad 0x35e38e3935e38e39,0x35e38e3935e38e39,0x35e1457935e19bd9,0x35e0842435e0e83b,0x35da76f535dbcd42,0x35d77aae35d9060a,0x35cf45aa35d23be2,0x35c8afa335cc16a0
.quad 0x35bfeb1d35c511a3,0x35b4882f35ba6711,0x35acb63735b4882f,0x359b8e2335a460c0,0x359609ad35a0e7f5,0x357cd8a0358a86ec,0x3578b412358a86ec,0x353bd3db355ae741
.quad 0x3540569935638e39,0x34eb9535351ba83c,0x35041c9e352e29da,0x34326f4c34b19357,0x348a775134eb9535,0xb3ee2023339ed037,0x329edc50346d9d9d,0xb4ceb09bb4462fa4
.quad 0xb46d9d9d1afb021f,0xb52e29dab4eb9535,0xb4f528c8b46d9d9d,0xb570545db5374b64,0xb5374b64b4eb9535,0xb59609adb57487f1,0xb570545db52e29da,0xb5afe71fb59609ad
.quad 0x0,0x0,0x329edc5000000000,0x336e40cb331ed9e5,0x331ed9e500000000,0x33ee2023339ed037,0x336e40cb00000000,0x34326f4c33ee2023
.quad 0x339ed03700000000,0x346d9d9d341ea985,0x33c67b3300000000,0x3494456534462fa4,0x33ee202300000000,0x34b19357346d9d9d,0x340adee900000000,0x34ceb09b348a7751
.quad 0x341ea98500000000,0x34eb9535349e0ef5,0x34326f4c00000000,0x35041c9e34b19357,0x34462fa400000000,0x35124a6934c50216,0x3459e9f200000000,0x3520501b34d858d4
.quad 0x346d9d9d00000000,0x352e29da34eb9535,0x3480a50600000000,0x353bd3db34feb4e3,0x348a775100000000,0x35494a5e3508dac4,0x3494456500000000,0x355689b335124a69
.quad 0x0,0x0,0x33c67b33339ed037,0x340adee933ee2023,0x34462fa4341ea985,0x348a7751346d9d9d,0x34944565346d9d9d,0x34ceb09b34b19357
.quad 0x34c50216349e0ef5,0x3508dac434eb9535,0x34f528c834c50216,0x3529910e35124a69,0x35124a6934eb9535,0x35494a5e352e29da,0x3529910e3508dac4,0x3567d76035494a5e
.quad 0x35405699351ba83c,0x3582854035638e39,0x355689b3352e29da,0x35905c16357cd8a0,0x356c197735405699,0x359d5b8e358a86ec,0x35807abd3552259d,0x35a97043359609ad
.quad 0x358a86ec35638e39,0x35b4882f35a0e7f5,0x359429a4357487f1,0x35be92c435ab15d8,0x359d5b8e35828540,0x35c7810935b4882f,0x35a615aa358a86ec,0x35cf45aa35bd349e
.quad 0x0,0x0,0x34326f4c341ea985,0x3459e9f234462fa4,0x34b19357349e0ef5,0x34d858d434c50216,0x35041c9e34eb9535,0x3520501b35124a69
.quad 0x352e29da351ba83c,0x3552259d35405699,0x355689b335405699,0x35807abd356c1977,0x357cd8a035638e39,0x359609ad358a86ec,0x35905c1635828540,0x35a97043359d5b8e
.quad 0x35a0e7f535924518,0x35ba671135ae5153,0x35afe71f35a0e7f5,0x35c8afa335bd349e,0x35bd349e35ae5153,0x35d4156535c9d820,0x35c8afa335ba6711,0x35dc6e6035d41565
.quad 0x35d23be235c511a3,0x35e19bd935dbcd42,0x35d9c1d135ce3c41,0x35e38ac235e0e83b,0x35df2ee235d5d510,0x35e233fb35e356c7,0x35e275b635dbcd42,0x35dd9c7235e3117f
.quad 0x0,0x0,0x3480a506346d9d9d,0x34944565348a7751,0x34feb4e334eb9535,0x35124a693508dac4,0x353bd3db352e29da,0x355689b335494a5e
.quad 0x357487f135638e39,0x358a86ec35828540,0x359429a4358a86ec,0x35a615aa359d5b8e,0x35ab15d835a0e7f5,0x35bd349e35b4882f,0x35be92c435b4882f,0x35cf45aa35c78109
.quad 0x35ce3c4135c511a3,0x35dbcd4235d5d510,0x35d9c1d135d23be2,0x35e275b635df2ee2,0x35e0e83b35dbcd42,0x35e3117f35e356c7,0x35e38ac235e19bd9,0x35dd9c7235e233fb
.quad 0x35e19bd935e38e39,0x35d23be235dbcd42,0x35db257235e19bd9,0x35c13d9d35d048c2,0x35d048c235dbcd42,0x35ab15d835bfeb1d,0x35c13d9d35d23be2,0x35905c1635ab15d8
.quad 0x35e0193635e38e39,0x35c511a335d5d510,0x35dfa77435e38e39,0x35c13d9d35d41565,0x35df2ee235e38e39,0x35bd349e35d23be2,0x35deaf8435e38e39,0x35b8f7c035d048c2
.quad 0x35de295d35e38e39,0x35b4882f35ce3c41,0x35dd9c7235e38e39,0x35afe71f35cc16a0,0x35dd08c735e38e39,0x35ab15d835c9d820,0x35dc6e6035e38e39,0x35a615aa35c78109
.quad 0x35e0193635e38e39,0x35c511a335d5d510,0x35dfa77435e38e39,0x35c13d9d35d41565,0x35df2ee235e38e39,0x35bd349e35d23be2,0x35deaf8435e38e39,0x35b8f7c035d048c2
.quad 0x35de295d35e38e39,0x35b4882f35ce3c41,0x35dd9c7235e38e39,0x35afe71f35cc16a0,0x35dd08c735e38e39,0x35ab15d835c9d820,0x35dc6e6035e38e39,0x35a615aa35c78109
.quad 0x3592451835ae5153,0x351ba83c35638e39,0x35888caf35a7c585,0x34f528c835494a5e,0x357cd8a035a0e7f5,0x34b19357352e29da,0x3567d7603599bbfb,0x3459e9f235124a69
.quad 0x3552259d35924518,0x339ed03734eb9535,0x353bd3db358a86ec,0xb36e40cb34b19357,0x3524f31835828540,0xb4462fa4346d9d9d,0x350d94bf357487f1,0xb4a7d3b533ee2023
.quad 0x3592451835ae5153,0x351ba83c35638e39,0x35888caf35a7c585,0x34f528c835494a5e,0x357cd8a035a0e7f5,0x34b19357352e29da,0x3567d7603599bbfb,0x3459e9f235124a69
.quad 0x3552259d35924518,0x339ed03734eb9535,0x353bd3db358a86ec,0xb36e40cb34b19357,0x3524f31835828540,0xb4462fa4346d9d9d,0x350d94bf357487f1,0xb4a7d3b533ee2023
.quad 0x1afb021f349e0ef5,0xb51ba83cb49e0ef5,0xb4326f4c341ea985,0xb54dbb20b4feb4e3,0xb4b193571afb021f,0xb57cd8a0b52e29da,0xb5041c9eb41ea985,0xb59429a4b55ae741
.quad 0xb52e29dab49e0ef5,0xb5a7c585b5828540,0xb55689b3b4eb9535,0xb5b8f7c0b59609ad,0xb57cd8a0b51ba83c,0xb5c78109b5a7c585,0xb5905c16b5405699,0xb5d32bdbb5b782ce
.quad 0x1afb021f349e0ef5,0xb51ba83cb49e0ef5,0xb4326f4c341ea985,0xb54dbb20b4feb4e3,0xb4b193571afb021f,0xb57cd8a0b52e29da,0xb5041c9eb41ea985,0xb59429a4b55ae741
.quad 0xb52e29dab49e0ef5,0xb5a7c585b5828540,0xb55689b3b4eb9535,0xb5b8f7c0b59609ad,0xb57cd8a0b51ba83c,0xb5c78109b5a7c585,0xb5905c16b5405699,0xb5d32bdbb5b782ce
.quad 0xb5924518b5638e39,0xb5c511a3b5ae5153,0xb5a97043b58a86ec,0xb5d4f879b5c28a3a,0xb5bd349eb5a0e7f5,0xb5df2ee2b5d23be2,0xb5cd2c91b5b4882f,0xb5e36f08b5dd08c7
.quad 0xb5d9060ab5c511a3,0xb5e19bd9b5e2b08c,0xb5e08424b5d23be2,0xb5d9c1d1b5e3117f,0xb5e3805cb5dbcd42,0xb5cc16a0b5de295d,0xb5e1eb5bb5e19bd9,0xb5b8f7c0b5d41565
.quad 0xb5924518b5638e39,0xb5c511a3b5ae5153,0xb5a97043b58a86ec,0xb5d4f879b5c28a3a,0xb5bd349eb5a0e7f5,0xb5df2ee2b5d23be2,0xb5cd2c91b5b4882f,0xb5e36f08b5dd08c7
.quad 0xb5d9060ab5c511a3,0xb5e19bd9b5e2b08c,0xb5e08424b5d23be2,0xb5d9c1d1b5e3117f,0xb5e3805cb5dbcd42,0xb5cc16a0b5de295d,0xb5e1eb5bb5e19bd9,0xb5b8f7c0b5d41565
.quad 0x349e0ef500000000,0x35638e39351ba83c,0x34a7d3b500000000,0x3570545d3524f318,0x34b1935700000000,0x357cd8a0352e29da,0x34bb4d9100000000,0x35848bc935374b64
.quad 0x34c5021600000000,0x358a86ec35405699,0x34ceb09b00000000,0x35905c1635494a5e,0x34d858d400000000,0x359609ad3552259d,0x34e1fa7600000000,0x359b8e23355ae741
.quad 0x349e0ef500000000,0x35638e39351ba83c,0x34a7d3b500000000,0x3570545d3524f318,0x34b1935700000000,0x357cd8a0352e29da,0x34bb4d9100000000,0x35848bc935374b64
.quad 0x34c5021600000000,0x358a86ec35405699,0x34ceb09b00000000,0x35905c1635494a5e,0x34d858d400000000,0x359609ad3552259d,0x34e1fa7600000000,0x359b8e23355ae741
.quad 0x35ae515335924518,0x35d5d51035c511a3,0x35b608443599bbfb,0x35db257235cc16a0,0x35bd349e35a0e7f5,0x35df2ee235d23be2,0x35c3d0ea35a7c585,0x35e1eb5b35d77aae
.quad 0x35c9d82035ae5153,0x35e356c735dbcd42,0x35cf45aa35b4882f,0x35e36f0835df2ee2,0x35d4156535ba6711,0x35e233fb35e19bd9,0x35d843a735bfeb1d,0x35dfa77435e3117f
.quad 0x35ae515335924518,0x35d5d51035c511a3,0x35b608443599bbfb,0x35db257235cc16a0,0x35bd349e35a0e7f5,0x35df2ee235d23be2,0x35c3d0ea35a7c585,0x35e1eb5b35d77aae
.quad 0x35c9d82035ae5153,0x35e356c735dbcd42,0x35cf45aa35b4882f,0x35e36f0835df2ee2,0x35d4156535ba6711,0x35e233fb35e19bd9,0x35d843a735bfeb1d,0x35dfa77435e3117f
.quad 0x35e38e3935e01936,0x35d5d51035e01936,0x35e275b635e2b08c,0x35cafa7735da76f5,0x35df2ee235e38e39,0x35bd349e35d23be2,0x35d9c1d135e2b08c,0x35acb63735c78109
.quad 0x35d23be235e01936,0x3599bbfb35ba6711,0x35c8afa335dbcd42,0x35848bc935ab15d8,0x35bd349e35d5d510,0x355ae7413599bbfb,0x35afe71f35ce3c41,0x3529910e35868e49
.quad 0x35e38e3935e01936,0x35d5d51035e01936,0x35e275b635e2b08c,0x35cafa7735da76f5,0x35df2ee235e38e39,0x35bd349e35d23be2,0x35d9c1d135e2b08c,0x35acb63735c78109
.quad 0x35d23be235e01936,0x3599bbfb35ba6711,0x35c8afa335dbcd42,0x35848bc935ab15d8,0x35bd349e35d5d510,0x355ae7413599bbfb,0x35afe71f35ce3c41,0x3529910e35868e49
.quad 0x35ae515335c511a3,0x35638e3935924518,0x3597e52535b4882f,0x3520501b356c1977,0x357cd8a035a0e7f5,0x34b19357352e29da,0x3544d37b358a86ec,0x336e40cb34d858d4
.quad 0x3508dac435638e39,0xb46d9d9d341ea985,0x34944565352e29da,0xb5041c9eb3ee2023,0x331ed9e534eb9535,0xb5494a5eb4c50216,0xb459e9f2346d9d9d,0xb5848bc9b524f318
.quad 0x35ae515335c511a3,0x35638e3935924518,0x3597e52535b4882f,0x3520501b356c1977,0x357cd8a035a0e7f5,0x34b19357352e29da,0x3544d37b358a86ec,0x336e40cb34d858d4
.quad 0x3508dac435638e39,0xb46d9d9d341ea985,0x34944565352e29da,0xb5041c9eb3ee2023,0x331ed9e534eb9535,0xb5494a5eb4c50216,0xb459e9f2346d9d9d,0xb5848bc9b524f318
.quad 0x3f8000003f80,0x3f8000003f80,0x3e853f7700003f80,0x3f353f353f003f5e,0x3f003f5e00003f80,0x3f80248d3f5e3f00,0x3f353f3500003f80,0x3f35bf353f80248d
.quad 0x3f5e3f0000003f80,0x250dbf803f5ebf00,0x3f773e8500003f80,0xbf35bf353f00bf5e,0x3f80248d00003f80,0xbf80a554250dbf80,0x3f77be8500003f80,0xbf353f35bf00bf5e
.quad 0x3f5ebf0000003f80,0x3f80bf5ebf00,0x3f35bf3500003f80,0x3f353f35bf80a554,0x3f00bf5e00003f80,0x3f80248dbf5e3f00,0x3e85bf7700003f80,0x3f35bf35bf003f5e
.quad 0x250dbf8000003f80,0x250dbf8000003f80,0xbe85bf7700003f80,0xbf35bf353f003f5e,0xbf00bf5e00003f80,0xbf80a5543f5e3f00,0xbf35bf3500003f80,0xbf353f353f80248d
.quad 0x3f8000003f80,0x3f8000003f80,0x3f773e853f5e3f00,0x3f77be853f80248d,0x3f00bf5e3f5ebf00,0xbf00bf5e250dbf80,0xbf35bf35250dbf80,0xbf353f35bf80a554
.quad 0xbf5e3f00bf5ebf00,0x3f5e3f0000003f80,0x3e853f77bf5e3f00,0x3e85bf773f80248d,0x3f80248d00003f80,0xbf80a554250dbf80,0x3e85bf773f5e3f00,0x3e853f77bf80a554
.quad 0xbf5ebf003f5ebf00,0x3f5ebf0000003f80,0xbf353f35250dbf80,0xbf35bf353f80248d,0x3f003f5ebf5ebf00,0xbf003f5e250dbf80,0x3f77be85bf5e3f00,0x3f773e85bf80a554
.quad 0x250dbf8000003f80,0x250dbf8000003f80,0xbf77be853f5e3f00,0xbf773e853f80248d,0xbf003f5e3f5ebf00,0x3f003f5e250dbf80,0x3f353f35250dbf80,0x3f35bf35bf80a554
.quad 0x3f8000003f80,0x3f8000003f80,0x3f35bf353f5ebf00,0x3e85bf773f00bf5e,0xbf80a554bf5ebf00,0xbf003f5ebf5e3f00,0x3f353f3500003f80,0x3f35bf353f80248d
.quad 0x250dbf803f5ebf00,0xbf5e3f00bf5ebf00,0xbf353f35bf5ebf00,0x3f77be853f003f5e,0x3f80248d00003f80,0xbf80a554250dbf80,0xbf35bf353f5ebf00,0x3f773e85bf003f5e
.quad 0x3f80bf5ebf00,0xbf5ebf003f5ebf00,0x3f35bf3500003f80,0x3f353f35bf80a554,0xbf80a5543f5ebf00,0xbf00bf5e3f5e3f00,0x3f353f35bf5ebf00,0x3e853f77bf00bf5e
.quad 0x250dbf8000003f80,0x250dbf8000003f80,0xbf353f353f5ebf00,0xbe853f773f00bf5e,0x3f80248dbf5ebf00,0x3f00bf5ebf5e3f00,0xbf35bf3500003f80,0xbf353f353f80248d
.quad 0x3f80,0x0,0x250dbf80,0x0,0x3f80,0x0,0x250dbf80,0x0
.quad 0x3f80,0x0,0x250dbf80,0x0,0x3f80,0x0,0x250dbf80,0x0
.quad 0x3f80,0x0,0x250dbf80,0x0,0x3f80,0x0,0x250dbf80,0x0
.quad 0x3f80,0x0,0x250dbf80,0x0,0x3f80,0x0,0x250dbf80,0x0
.quad 0xbf5ebf0000003f80,0x3f803f5ebf00,0xbf77be8500003f80,0x3f353f353f00bf5e,0xbf80a55400003f80,0x3f80248d250dbf80,0xbf773e8500003f80,0x3f35bf35bf00bf5e
.quad 0xbf5e3f0000003f80,0x250dbf80bf5ebf00,0xbf353f3500003f80,0xbf35bf35bf80a554,0xbf003f5e00003f80,0xbf80a554bf5e3f00,0xbe853f7700003f80,0xbf353f35bf003f5e
.quad 0x0,0x0,0x0,0x0,0x0,0x0,0x0,0x0
.quad 0x0,0x0,0x0,0x0,0x0,0x0,0x0,0x0
.quad 0x3f5ebf00bf5ebf00,0xbf5ebf0000003f80,0xbe85bf77bf5e3f00,0xbe853f773f80248d,0xbf80a55400003f80,0x3f80248d250dbf80,0xbe853f773f5e3f00,0xbe85bf77bf80a554
.quad 0x3f5e3f003f5ebf00,0xbf5e3f0000003f80,0x3f35bf35250dbf80,0x3f353f353f80248d,0xbf00bf5ebf5ebf00,0x3f00bf5e250dbf80,0xbf773e85bf5e3f00,0xbf77be85bf80a554
.quad 0x0,0x0,0x0,0x0,0x0,0x0,0x0,0x0
.quad 0x0,0x0,0x0,0x0,0x0,0x0,0x0,0x0
.quad 0x3f803f5ebf00,0x3f5ebf00bf5ebf00,0x3f35bf35bf5ebf00,0xbf773e853f003f5e,0xbf80a55400003f80,0x3f80248d250dbf80,0x3f353f353f5ebf00,0xbf77be85bf003f5e
.quad 0x250dbf80bf5ebf00,0x3f5e3f003f5ebf00,0xbf353f3500003f80,0xbf35bf35bf80a554,0x3f80248d3f5ebf00,0x3f003f5e3f5e3f00,0xbf35bf35bf5ebf00,0xbe85bf77bf00bf5e
.quad 0x0,0x0,0x0,0x0,0x0,0x0,0x0,0x0
.quad 0x0,0x0,0x0,0x0,0x0,0x0,0x0,0x0
.quad 0x3f80,0x0,0x250dbf80,0x0,0x3f80,0x0,0x250dbf80,0x0
.quad 0x3f80,0x0,0x250dbf80,0x0,0x3f80,0x0,0x250dbf80,0x0
.quad 0x0,0x0,0x0,0x0,0x0,0x0,0x0,0x0
.quad 0x0,0x0,0x0,0x0,0x0,0x0,0x0,0x0
.fill 3840, 4, 0
.size L_tables, 57344
.section .rodata,"a"
.p2align 6
.amdhsa_kernel concat_heads__ssm_conv_s4d__spectral_gfnet__prompt_kernel
  .amdhsa_next_free_vgpr 128
  .amdhsa_next_free_sgpr 100
  .amdhsa_accum_offset 128
  .amdhsa_group_segment_fixed_size 0
  .amdhsa_kernarg_size 104
  .amdhsa_user_sgpr_count 2
  .amdhsa_user_sgpr_kernarg_segment_ptr 1
  .amdhsa_system_sgpr_workgroup_id_x 1
.end_amdhsa_kernel
```
